```python
import torch

def _softmax(x, axis=-1):
    return torch.softmax(x, dim=axis)
def _gelu(x):
    return torch.nn.functional.gelu(x, approximate="tanh")
def _silu(x):
    return torch.nn.functional.silu(x)
def _sigmoid(x):
    return torch.sigmoid(x)
def _layernorm(x, axis=-1, eps=1e-5):
    m = x.mean(dim=axis, keepdim=True)
    v = x.var(dim=axis, keepdim=True, unbiased=False)
    return (x - m) / torch.sqrt(v + eps)
def _scatter_add(tgt, idx, src, axis=0):
    return tgt.clone().index_add_(axis, idx, src)
def _segment_sum(src, seg, n):
    out = torch.zeros((n,) + src.shape[1:], dtype=src.dtype)
    return out.index_add_(0, seg, src)
def _pad(x, pw):
    flat = tuple(v for pair in reversed(pw) for v in pair)
    return torch.nn.functional.pad(x, flat)

kernel_name = 'sequential_preLN__mha_block_cached__dense_activation_silu__decode'

def setup_inputs():

    _w = (lambda a: (lambda t: t.to(torch.bfloat16) if t.is_floating_point() else t)(torch.as_tensor(a)))
    def _A_setup():
        B, Sq, D = 1, 1, 512
        H, Sk, Dh = 32, 65536, 128
        return {
            "x": _w((lambda *s: torch.randn(*s, dtype=torch.bfloat16) * 0.1)(B, Sq, D)),
            "k_cache": _w((lambda *s: torch.randn(*s, dtype=torch.bfloat16) * 1.6)(B, H, Sk, Dh)),
            "v_cache": _w((lambda *s: torch.randn(*s, dtype=torch.bfloat16) * 1.6)(B, H, Sk, Dh)),
            "wq": _w((lambda *s: torch.randn(*s, dtype=torch.bfloat16) * 1.6)(D, H * Dh) * (D ** -0.5)),
            "wo": _w((lambda *s: torch.randn(*s, dtype=torch.bfloat16) * 1.6)(H * Dh, D) * ((H * Dh) ** -0.5)),
        }
    _A_in = _A_setup()

    def _B_setup():
        B, S, D, F = 1, 1, 512, 1792
        return {
            "x": _w((lambda *s: torch.randn(*s, dtype=torch.bfloat16) * 0.1)(B, S, D)),
            "w1": _w((lambda *s: torch.randn(*s, dtype=torch.bfloat16) * 3.2)(D, F) * (D ** -0.5)),
            "w2": _w((lambda *s: torch.randn(*s, dtype=torch.bfloat16) * 3.2)(F, D) * (F ** -0.5)),
        }
    _B_in = _B_setup()

    return {
        "A_x": _A_in["x"],
        "A_k_cache": _A_in["k_cache"],
        "A_v_cache": _A_in["v_cache"],
        "A_wq": _A_in["wq"],
        "A_wo": _A_in["wo"],
        "B_x": _B_in["x"],
        "B_w1": _B_in["w1"],
        "B_w2": _B_in["w2"],
    }

def reference(A_x, A_k_cache, A_v_cache, A_wq, A_wo, B_x, B_w1, B_w2):
    def _A_ref(x, k_cache, v_cache, wq, wo):
        B, Sq, D = x.shape
        H, Dh = 32, 128
        q = (lambda x, *d: x.permute(*d))((x @ wq).reshape(B, Sq, H, Dh), 0, 2, 1, 3)
        scores = torch.einsum("bhqd,bhkd->bhqk", q, k_cache) * (Dh ** -0.5)
        p = _softmax(scores, axis=-1)
        o = torch.einsum("bhqk,bhkd->bhqd", p, v_cache)
        return (lambda x, *d: x.permute(*d))(o, 0, 2, 1, 3).reshape(B, Sq, H * Dh) @ wo

    def _B_ref(x, w1, w2):
        h = torch.einsum("bsd,df->bsf", x, w1)
        h = _silu(h)
        out = torch.einsum("bsf,fd->bsd", h, w2)
        return out

    x = A_x
    h = x + _A_ref(_layernorm(x, axis=-1), A_k_cache, A_v_cache, A_wq, A_wo)
    h2 = h + _B_ref(_layernorm(h, axis=-1), B_w1, B_w2)
    return h2
```

```asm
; @launch grid=(256,1,1) block=(512,1,1) lds=38400
.amdgcn_target "amdgcn-amd-amdhsa--gfx950"
.text
.globl sequential_preLN__mha_block_cached__dense_activation_silu__decode_kernel
.p2align 8
.type sequential_preLN__mha_block_cached__dense_activation_silu__decode_kernel,@function
sequential_preLN__mha_block_cached__dense_activation_silu__decode_kernel:
    s_cmpk_ge_u32 s2, 0x100
    s_cbranch_scc1 L_end
    s_load_dwordx4 s[16:19], s[0:1], 8
    v_readfirstlane_b32 s3, v0
    v_and_b32 v0, 63, v0
    s_and_b32 s4, s2, 7
    s_lshl_b32 s4, s4, 5
    s_lshr_b32 s5, s2, 3
    s_add_u32 s4, s4, s5
    s_cmpk_ge_u32 s3, 0x100
    s_cbranch_scc1 L_H
    s_and_b32 s5, s3, 64
    s_lshl_b32 s5, s5, 6
    s_and_b32 s6, s3, 128
    s_lshl_b32 s6, s6, 7
    s_or_b32 s5, s5, s6
    v_lshl_add_u32 v1, v0, 4, s5
    s_lshl_b32 s6, s4, 21
    s_mov_b32 s42, 0x200000
    s_mov_b32 s43, 0x20000
    s_waitcnt lgkmcnt(0)
    s_add_u32 s40, s16, s6
    s_addc_u32 s41, s17, 0
    s_mov_b32 s48, 0
    buffer_load_dwordx4 v[104:107], v1, s[40:43], s48 offen nt
    s_mov_b32 s48, 8192
    buffer_load_dwordx4 v[108:111], v1, s[40:43], s48 offen nt
    s_mov_b32 s48, 32768
    buffer_load_dwordx4 v[112:115], v1, s[40:43], s48 offen nt
    s_mov_b32 s48, 40960
    buffer_load_dwordx4 v[116:119], v1, s[40:43], s48 offen nt
    s_mov_b32 s48, 2048
    buffer_load_dwordx4 v[120:123], v1, s[40:43], s48 offen nt
    s_branch L_S
L_H:
    s_load_dwordx2 s[20:21], s[0:1], 0
    s_load_dwordx4 s[24:27], s[0:1], 24
    s_load_dwordx2 s[36:37], s[0:1], 80
    s_lshr_b32 s3, s3, 6
    s_sub_u32 s7, s3, 4
    s_lshr_b32 s8, s4, 3
    v_lshlrev_b32 v1, 4, v0
    v_lshrrev_b32 v2, 4, v0
    v_and_b32 v3, 15, v0
    s_cmp_lg_u32 s7, 0
    s_cbranch_scc1 L_H123
    v_lshlrev_b32 v30, 13, v2
    v_lshl_add_u32 v30, v3, 4, v30
    s_and_b32 s6, s4, 7
    v_lshl_add_u32 v31, v3, 2, v2
    s_lshl_b32 s5, s6, 6
    v_add_lshl_u32 v31, v31, s5, 1
    s_lshl_b32 s48, s6, 19
    s_lshl_b32 s5, s8, 8
    s_add_u32 s48, s48, s5
    s_movk_i32 s22, 0x400
    s_mov_b32 s23, 0x20000
    s_mov_b32 s46, 0x400000
    s_mov_b32 s47, 0x20000
    s_waitcnt lgkmcnt(0)
    s_mov_b64 s[44:45], s[24:25]
    buffer_load_dwordx4 v[24:27], v1, s[20:23], 0 offen
    buffer_load_ushort v29, v31, s[20:23], 0 offen
    buffer_load_dwordx4 v[64:67], v30, s[44:47], s48 offen nt
    s_add_u32 s48, s48, 32768
    buffer_load_dwordx4 v[68:71], v30, s[44:47], s48 offen nt
    s_add_u32 s48, s48, 32768
    buffer_load_dwordx4 v[72:75], v30, s[44:47], s48 offen nt
    s_add_u32 s48, s48, 32768
    buffer_load_dwordx4 v[76:79], v30, s[44:47], s48 offen nt
    s_add_u32 s48, s48, 32768
    buffer_load_dwordx4 v[80:83], v30, s[44:47], s48 offen nt
    s_add_u32 s48, s48, 32768
    buffer_load_dwordx4 v[84:87], v30, s[44:47], s48 offen nt
    s_add_u32 s48, s48, 32768
    buffer_load_dwordx4 v[88:91], v30, s[44:47], s48 offen nt
    s_add_u32 s48, s48, 32768
    buffer_load_dwordx4 v[92:95], v30, s[44:47], s48 offen nt
    s_add_u32 s48, s48, 32768
    buffer_load_dwordx4 v[96:99], v30, s[44:47], s48 offen nt
    s_add_u32 s48, s48, 32768
    buffer_load_dwordx4 v[100:103], v30, s[44:47], s48 offen nt
    s_add_u32 s48, s48, 32768
    buffer_load_dwordx4 v[104:107], v30, s[44:47], s48 offen nt
    s_add_u32 s48, s48, 32768
    buffer_load_dwordx4 v[108:111], v30, s[44:47], s48 offen nt
    s_add_u32 s48, s48, 32768
    buffer_load_dwordx4 v[112:115], v30, s[44:47], s48 offen nt
    s_add_u32 s48, s48, 32768
    buffer_load_dwordx4 v[116:119], v30, s[44:47], s48 offen nt
    s_add_u32 s48, s48, 32768
    buffer_load_dwordx4 v[120:123], v30, s[44:47], s48 offen nt
    s_add_u32 s48, s48, 32768
    buffer_load_dwordx4 v[124:127], v30, s[44:47], s48 offen nt
    s_branch L_Hc
L_S:
    s_load_dwordx2 s[36:37], s[0:1], 80
    s_lshr_b32 s3, s3, 6
    s_add_u32 s44, s18, s6
    s_addc_u32 s45, s19, 0
    s_mov_b32 s47, 0
    s_lshl_b32 s5, s3, 2
    s_add_u32 s5, s5, 35072
    v_mov_b32 v38, s5
    v_mov_b32 v233, 0
    v_add_u32 v232, 144, v38
    s_mov_b32 s50, 0x22222222
    s_mov_b32 s51, s50
    s_mov_b32 s52, 0x44444444
    s_mov_b32 s53, s52
    s_mov_b32 s54, 0x88888888
    s_mov_b32 s55, s54
    s_mov_b32 s56, 0x3db504f3
    s_mov_b32 s57, 0x3fb8aa3b
    v_and_b32 v20, 1, v0
    v_lshlrev_b32 v20, 4, v20
    v_mov_b32 v21, 0xffff
    v_lshlrev_b32 v20, v20, v21
    v_bfe_u32 v21, v0, 1, 3
    v_cmp_eq_u32 vcc, 0, v21
    s_nop 1
    v_cndmask_b32 v8, 0, v20, vcc
    v_cmp_eq_u32 vcc, 1, v21
    s_nop 1
    v_cndmask_b32 v9, 0, v20, vcc
    v_cmp_eq_u32 vcc, 2, v21
    s_nop 1
    v_cndmask_b32 v10, 0, v20, vcc
    v_cmp_eq_u32 vcc, 3, v21
    s_nop 1
    v_cndmask_b32 v11, 0, v20, vcc
    s_lshl_b32 s5, s3, 13
    v_lshl_add_u32 v2, v0, 2, s5
    v_and_b32 v3, 15, v0
    v_lshlrev_b32 v3, 4, v3
    v_mov_b32 v35, 0xff800000
    s_waitcnt lgkmcnt(0)
    s_mov_b32 s60, s36
    s_mov_b32 s61, s37
    s_mov_b32 s62, 638976
    s_mov_b32 s63, 0x20000
    s_waitcnt vmcnt(4)
    s_mov_b32 s48, 10240
    buffer_load_dwordx4 v[124:127], v1, s[40:43], s48 offen nt
    s_waitcnt vmcnt(4)
    s_mov_b32 s48, 34816
    buffer_load_dwordx4 v[128:131], v1, s[40:43], s48 offen nt
    s_waitcnt vmcnt(4)
    s_mov_b32 s48, 43008
    buffer_load_dwordx4 v[132:135], v1, s[40:43], s48 offen nt
    s_waitcnt vmcnt(4)
    s_or_b32 s48, s47, 65536
    buffer_load_dwordx4 v[136:139], v1, s[40:43], s48 offen nt
    s_waitcnt vmcnt(4)
    s_or_b32 s48, s47, 73728
    buffer_load_dwordx4 v[140:143], v1, s[40:43], s48 offen nt
    s_waitcnt vmcnt(4)
    s_or_b32 s48, s47, 98304
    buffer_load_dwordx4 v[144:147], v1, s[40:43], s48 offen nt
    s_waitcnt vmcnt(4)
    s_or_b32 s48, s47, 106496
    buffer_load_dwordx4 v[148:151], v1, s[40:43], s48 offen nt
    s_waitcnt vmcnt(4)
    s_or_b32 s48, s47, 67584
    buffer_load_dwordx4 v[152:155], v1, s[40:43], s48 offen nt
    s_waitcnt vmcnt(4)
    s_or_b32 s48, s47, 75776
    buffer_load_dwordx4 v[156:159], v1, s[40:43], s48 offen nt
    s_waitcnt vmcnt(4)
    s_or_b32 s48, s47, 100352
    buffer_load_dwordx4 v[160:163], v1, s[40:43], s48 offen nt
    s_waitcnt vmcnt(4)
    s_or_b32 s48, s47, 108544
    buffer_load_dwordx4 v[164:167], v1, s[40:43], s48 offen nt
    s_waitcnt vmcnt(4)
    s_or_b32 s47, s47, 0xffe1fbff
    s_add_u32 s47, s47, 1
    s_and_b32 s47, s47, 0x1e0400
    buffer_load_dwordx4 v[168:171], v1, s[40:43], s47 offen nt
    s_waitcnt vmcnt(4)
    s_or_b32 s48, s47, 8192
    buffer_load_dwordx4 v[172:175], v1, s[40:43], s48 offen nt
    s_waitcnt vmcnt(4)
    s_or_b32 s48, s47, 32768
    buffer_load_dwordx4 v[176:179], v1, s[40:43], s48 offen nt
    s_waitcnt vmcnt(4)
    s_or_b32 s48, s47, 40960
    buffer_load_dwordx4 v[180:183], v1, s[40:43], s48 offen nt
    s_waitcnt vmcnt(4)
    s_or_b32 s48, s47, 2048
    buffer_load_dwordx4 v[184:187], v1, s[40:43], s48 offen nt
    s_waitcnt vmcnt(4)
    s_or_b32 s48, s47, 10240
    buffer_load_dwordx4 v[188:191], v1, s[40:43], s48 offen nt
    s_waitcnt vmcnt(4)
    s_or_b32 s48, s47, 34816
    buffer_load_dwordx4 v[192:195], v1, s[40:43], s48 offen nt
    s_waitcnt vmcnt(4)
    s_or_b32 s48, s47, 43008
    buffer_load_dwordx4 v[196:199], v1, s[40:43], s48 offen nt
    s_waitcnt vmcnt(4)
    s_or_b32 s48, s47, 65536
    buffer_load_dwordx4 v[200:203], v1, s[40:43], s48 offen nt
    s_waitcnt vmcnt(4)
    s_or_b32 s48, s47, 73728
    buffer_load_dwordx4 v[204:207], v1, s[40:43], s48 offen nt
    s_waitcnt vmcnt(4)
    s_or_b32 s48, s47, 98304
    buffer_load_dwordx4 v[208:211], v1, s[40:43], s48 offen nt
    s_waitcnt vmcnt(4)
    s_or_b32 s48, s47, 106496
    buffer_load_dwordx4 v[212:215], v1, s[40:43], s48 offen nt
    s_waitcnt vmcnt(4)
    s_or_b32 s48, s47, 67584
    buffer_load_dwordx4 v[216:219], v1, s[40:43], s48 offen nt
    s_waitcnt vmcnt(4)
    s_or_b32 s48, s47, 75776
    buffer_load_dwordx4 v[220:223], v1, s[40:43], s48 offen nt
    s_waitcnt vmcnt(4)
    s_or_b32 s48, s47, 100352
    buffer_load_dwordx4 v[224:227], v1, s[40:43], s48 offen nt
    s_waitcnt vmcnt(4)
    s_or_b32 s48, s47, 108544
    buffer_load_dwordx4 v[228:231], v1, s[40:43], s48 offen nt
    s_waitcnt vmcnt(4)
    s_or_b32 s47, s47, 0xffe1fbff
    s_add_u32 s47, s47, 1
    s_and_b32 s47, s47, 0x1e0400
    buffer_load_dwordx4 v[40:43], v1, s[40:43], s47 offen nt
    s_waitcnt vmcnt(4)
    s_or_b32 s48, s47, 8192
    buffer_load_dwordx4 v[44:47], v1, s[40:43], s48 offen nt
    s_waitcnt vmcnt(4)
    s_or_b32 s48, s47, 32768
    buffer_load_dwordx4 v[48:51], v1, s[40:43], s48 offen nt
    s_waitcnt vmcnt(4)
    s_or_b32 s48, s47, 40960
    buffer_load_dwordx4 v[52:55], v1, s[40:43], s48 offen nt
    s_waitcnt vmcnt(4)
    s_or_b32 s48, s47, 2048
    buffer_load_dwordx4 v[56:59], v1, s[40:43], s48 offen nt
    s_waitcnt vmcnt(4)
    s_or_b32 s48, s47, 10240
    buffer_load_dwordx4 v[60:63], v1, s[40:43], s48 offen nt
    s_barrier
    ds_read_b128 v[4:7], v3 offset:32768
    s_waitcnt lgkmcnt(0)
    s_waitcnt vmcnt(4)
    s_or_b32 s48, s47, 34816
    buffer_load_dwordx4 v[64:67], v1, s[40:43], s48 offen nt
    v_dot2_f32_bf16 v20, v104, v4, 0
    v_dot2_f32_bf16 v20, v105, v5, v20
    v_dot2_f32_bf16 v20, v106, v6, v20
    v_dot2_f32_bf16 v20, v107, v7, v20
    v_dot2_f32_bf16 v21, v108, v4, 0
    v_dot2_f32_bf16 v21, v109, v5, v21
    v_dot2_f32_bf16 v21, v110, v6, v21
    v_dot2_f32_bf16 v21, v111, v7, v21
    v_dot2_f32_bf16 v22, v112, v4, 0
    v_dot2_f32_bf16 v22, v113, v5, v22
    v_dot2_f32_bf16 v22, v114, v6, v22
    v_dot2_f32_bf16 v22, v115, v7, v22
    v_add_u32 v233, 4, v233
    ds_write_b32 v38, v233 offset:128
    v_dot2_f32_bf16 v23, v116, v4, 0
    v_dot2_f32_bf16 v23, v117, v5, v23
    v_dot2_f32_bf16 v23, v118, v6, v23
    v_dot2_f32_bf16 v23, v119, v7, v23
    v_dot2_f32_bf16 v24, v120, v4, 0
    v_dot2_f32_bf16 v24, v121, v5, v24
    v_dot2_f32_bf16 v24, v122, v6, v24
    v_dot2_f32_bf16 v24, v123, v7, v24
    v_add_f32_dpp v28, v20, v20 row_ror:8 row_mask:0xf bank_mask:0x3
    v_add_f32_dpp v29, v21, v21 row_ror:8 row_mask:0xf bank_mask:0x3
    v_add_f32_dpp v28, v22, v22 row_ror:8 row_mask:0xf bank_mask:0xc
    v_add_f32_dpp v29, v23, v23 row_ror:8 row_mask:0xf bank_mask:0xc
    s_nop 0
    v_add_f32_dpp v30, v28, v28 row_half_mirror row_mask:0xf bank_mask:0x5
    v_add_f32_dpp v30, v29, v29 row_half_mirror row_mask:0xf bank_mask:0xa
    s_nop 1
    v_add_f32_dpp v30, v30, v30 quad_perm:[1,0,3,2] row_mask:0xf bank_mask:0xf
    s_nop 1
    v_add_f32_dpp v30, v30, v30 quad_perm:[2,3,0,1] row_mask:0xf bank_mask:0xf
    v_dot2_f32_bf16 v25, v124, v4, 0
    v_dot2_f32_bf16 v25, v125, v5, v25
    v_dot2_f32_bf16 v25, v126, v6, v25
    v_dot2_f32_bf16 v25, v127, v7, v25
    ds_read_b32 v234, v232
    v_dot2_f32_bf16 v26, v128, v4, 0
    v_dot2_f32_bf16 v26, v129, v5, v26
    v_dot2_f32_bf16 v26, v130, v6, v26
    v_dot2_f32_bf16 v26, v131, v7, v26
    v_add_u32 v233, 4, v233
    ds_write_b32 v38, v233 offset:128
    v_dot2_f32_bf16 v27, v132, v4, 0
    v_dot2_f32_bf16 v27, v133, v5, v27
    v_dot2_f32_bf16 v27, v134, v6, v27
    v_dot2_f32_bf16 v27, v135, v7, v27
    s_waitcnt vmcnt(4)
    s_or_b32 s48, s47, 43008
    buffer_load_dwordx4 v[68:71], v1, s[40:43], s48 offen nt
    v_dot2_f32_bf16 v20, v136, v4, 0
    v_dot2_f32_bf16 v20, v137, v5, v20
    v_dot2_f32_bf16 v20, v138, v6, v20
    v_dot2_f32_bf16 v20, v139, v7, v20
    v_add_f32_dpp v28, v24, v24 row_ror:8 row_mask:0xf bank_mask:0x3
    v_add_f32_dpp v29, v25, v25 row_ror:8 row_mask:0xf bank_mask:0x3
    v_add_f32_dpp v28, v26, v26 row_ror:8 row_mask:0xf bank_mask:0xc
    v_add_f32_dpp v29, v27, v27 row_ror:8 row_mask:0xf bank_mask:0xc
    s_nop 0
    v_add_f32_dpp v31, v28, v28 row_half_mirror row_mask:0xf bank_mask:0x5
    v_add_f32_dpp v31, v29, v29 row_half_mirror row_mask:0xf bank_mask:0xa
    s_nop 1
    v_add_f32_dpp v31, v31, v31 quad_perm:[1,0,3,2] row_mask:0xf bank_mask:0xf
    s_nop 1
    v_add_f32_dpp v31, v31, v31 quad_perm:[2,3,0,1] row_mask:0xf bank_mask:0xf
    v_dot2_f32_bf16 v21, v140, v4, 0
    v_dot2_f32_bf16 v21, v141, v5, v21
    v_dot2_f32_bf16 v21, v142, v6, v21
    v_dot2_f32_bf16 v21, v143, v7, v21
    v_dot2_f32_bf16 v22, v144, v4, 0
    v_dot2_f32_bf16 v22, v145, v5, v22
    v_dot2_f32_bf16 v22, v146, v6, v22
    v_dot2_f32_bf16 v22, v147, v7, v22
    v_add_u32 v233, 4, v233
    ds_write_b32 v38, v233 offset:128
    v_dot2_f32_bf16 v23, v148, v4, 0
    v_dot2_f32_bf16 v23, v149, v5, v23
    v_dot2_f32_bf16 v23, v150, v6, v23
    v_dot2_f32_bf16 v23, v151, v7, v23
    v_dot2_f32_bf16 v24, v152, v4, 0
    v_dot2_f32_bf16 v24, v153, v5, v24
    v_dot2_f32_bf16 v24, v154, v6, v24
    v_dot2_f32_bf16 v24, v155, v7, v24
    v_add_f32_dpp v28, v20, v20 row_ror:8 row_mask:0xf bank_mask:0x3
    v_add_f32_dpp v29, v21, v21 row_ror:8 row_mask:0xf bank_mask:0x3
    v_add_f32_dpp v28, v22, v22 row_ror:8 row_mask:0xf bank_mask:0xc
    v_add_f32_dpp v29, v23, v23 row_ror:8 row_mask:0xf bank_mask:0xc
    s_nop 0
    v_add_f32_dpp v32, v28, v28 row_half_mirror row_mask:0xf bank_mask:0x5
    v_add_f32_dpp v32, v29, v29 row_half_mirror row_mask:0xf bank_mask:0xa
    s_nop 1
    v_add_f32_dpp v32, v32, v32 quad_perm:[1,0,3,2] row_mask:0xf bank_mask:0xf
    s_nop 1
    v_add_f32_dpp v32, v32, v32 quad_perm:[2,3,0,1] row_mask:0xf bank_mask:0xf
    v_dot2_f32_bf16 v25, v156, v4, 0
    v_dot2_f32_bf16 v25, v157, v5, v25
    v_dot2_f32_bf16 v25, v158, v6, v25
    v_dot2_f32_bf16 v25, v159, v7, v25
    ds_read_b32 v234, v232
    v_dot2_f32_bf16 v26, v160, v4, 0
    v_dot2_f32_bf16 v26, v161, v5, v26
    v_dot2_f32_bf16 v26, v162, v6, v26
    v_dot2_f32_bf16 v26, v163, v7, v26
    v_add_u32 v233, 4, v233
    ds_write_b32 v38, v233 offset:128
    v_dot2_f32_bf16 v27, v164, v4, 0
    v_dot2_f32_bf16 v27, v165, v5, v27
    v_dot2_f32_bf16 v27, v166, v6, v27
    v_dot2_f32_bf16 v27, v167, v7, v27
    v_add_f32_dpp v28, v24, v24 row_ror:8 row_mask:0xf bank_mask:0x3
    v_add_f32_dpp v29, v25, v25 row_ror:8 row_mask:0xf bank_mask:0x3
    v_add_f32_dpp v28, v26, v26 row_ror:8 row_mask:0xf bank_mask:0xc
    v_add_f32_dpp v29, v27, v27 row_ror:8 row_mask:0xf bank_mask:0xc
    s_nop 0
    v_add_f32_dpp v33, v28, v28 row_half_mirror row_mask:0xf bank_mask:0x5
    v_add_f32_dpp v33, v29, v29 row_half_mirror row_mask:0xf bank_mask:0xa
    s_nop 1
    v_add_f32_dpp v33, v33, v33 quad_perm:[1,0,3,2] row_mask:0xf bank_mask:0xf
    s_nop 1
    v_add_f32_dpp v33, v33, v33 quad_perm:[2,3,0,1] row_mask:0xf bank_mask:0xf
    v_cndmask_b32 v34, v30, v31, s[50:51]
    v_cndmask_b32 v34, v34, v32, s[52:53]
    v_cndmask_b32 v34, v34, v33, s[54:55]
    v_cvt_pk_bf16_f32 v34, v34, v34
    v_and_b32 v34, 0xffff0000, v34
    v_mul_f32 v34, s56, v34
    v_cvt_pk_bf16_f32 v34, v34, v34
    v_and_b32 v34, 0xffff0000, v34
    v_max_f32 v35, v35, v34
    ds_write_b32 v2, v34
    v_add_u32 v2, 256, v2
    s_waitcnt vmcnt(4)
    s_or_b32 s48, s47, 65536
    buffer_load_dwordx4 v[72:75], v1, s[40:43], s48 offen nt
    v_dot2_f32_bf16 v20, v168, v4, 0
    v_dot2_f32_bf16 v20, v169, v5, v20
    v_dot2_f32_bf16 v20, v170, v6, v20
    v_dot2_f32_bf16 v20, v171, v7, v20
    v_dot2_f32_bf16 v21, v172, v4, 0
    v_dot2_f32_bf16 v21, v173, v5, v21
    v_dot2_f32_bf16 v21, v174, v6, v21
    v_dot2_f32_bf16 v21, v175, v7, v21
    v_dot2_f32_bf16 v22, v176, v4, 0
    v_dot2_f32_bf16 v22, v177, v5, v22
    v_dot2_f32_bf16 v22, v178, v6, v22
    v_dot2_f32_bf16 v22, v179, v7, v22
    v_add_u32 v233, 4, v233
    ds_write_b32 v38, v233 offset:128
    v_dot2_f32_bf16 v23, v180, v4, 0
    v_dot2_f32_bf16 v23, v181, v5, v23
    v_dot2_f32_bf16 v23, v182, v6, v23
    v_dot2_f32_bf16 v23, v183, v7, v23
    v_dot2_f32_bf16 v24, v184, v4, 0
    v_dot2_f32_bf16 v24, v185, v5, v24
    v_dot2_f32_bf16 v24, v186, v6, v24
    v_dot2_f32_bf16 v24, v187, v7, v24
    v_add_f32_dpp v28, v20, v20 row_ror:8 row_mask:0xf bank_mask:0x3
    v_add_f32_dpp v29, v21, v21 row_ror:8 row_mask:0xf bank_mask:0x3
    v_add_f32_dpp v28, v22, v22 row_ror:8 row_mask:0xf bank_mask:0xc
    v_add_f32_dpp v29, v23, v23 row_ror:8 row_mask:0xf bank_mask:0xc
    s_nop 0
    v_add_f32_dpp v30, v28, v28 row_half_mirror row_mask:0xf bank_mask:0x5
    v_add_f32_dpp v30, v29, v29 row_half_mirror row_mask:0xf bank_mask:0xa
    s_nop 1
    v_add_f32_dpp v30, v30, v30 quad_perm:[1,0,3,2] row_mask:0xf bank_mask:0xf
    s_nop 1
    v_add_f32_dpp v30, v30, v30 quad_perm:[2,3,0,1] row_mask:0xf bank_mask:0xf
    v_dot2_f32_bf16 v25, v188, v4, 0
    v_dot2_f32_bf16 v25, v189, v5, v25
    v_dot2_f32_bf16 v25, v190, v6, v25
    v_dot2_f32_bf16 v25, v191, v7, v25
    ds_read_b32 v234, v232
    v_dot2_f32_bf16 v26, v192, v4, 0
    v_dot2_f32_bf16 v26, v193, v5, v26
    v_dot2_f32_bf16 v26, v194, v6, v26
    v_dot2_f32_bf16 v26, v195, v7, v26
    v_add_u32 v233, 4, v233
    ds_write_b32 v38, v233 offset:128
    v_dot2_f32_bf16 v27, v196, v4, 0
    v_dot2_f32_bf16 v27, v197, v5, v27
    v_dot2_f32_bf16 v27, v198, v6, v27
    v_dot2_f32_bf16 v27, v199, v7, v27
    s_waitcnt vmcnt(4)
    s_or_b32 s48, s47, 73728
    buffer_load_dwordx4 v[76:79], v1, s[40:43], s48 offen nt
    v_dot2_f32_bf16 v20, v200, v4, 0
    v_dot2_f32_bf16 v20, v201, v5, v20
    v_dot2_f32_bf16 v20, v202, v6, v20
    v_dot2_f32_bf16 v20, v203, v7, v20
    v_add_f32_dpp v28, v24, v24 row_ror:8 row_mask:0xf bank_mask:0x3
    v_add_f32_dpp v29, v25, v25 row_ror:8 row_mask:0xf bank_mask:0x3
    v_add_f32_dpp v28, v26, v26 row_ror:8 row_mask:0xf bank_mask:0xc
    v_add_f32_dpp v29, v27, v27 row_ror:8 row_mask:0xf bank_mask:0xc
    s_nop 0
    v_add_f32_dpp v31, v28, v28 row_half_mirror row_mask:0xf bank_mask:0x5
    v_add_f32_dpp v31, v29, v29 row_half_mirror row_mask:0xf bank_mask:0xa
    s_nop 1
    v_add_f32_dpp v31, v31, v31 quad_perm:[1,0,3,2] row_mask:0xf bank_mask:0xf
    s_nop 1
    v_add_f32_dpp v31, v31, v31 quad_perm:[2,3,0,1] row_mask:0xf bank_mask:0xf
    v_dot2_f32_bf16 v21, v204, v4, 0
    v_dot2_f32_bf16 v21, v205, v5, v21
    v_dot2_f32_bf16 v21, v206, v6, v21
    v_dot2_f32_bf16 v21, v207, v7, v21
    v_dot2_f32_bf16 v22, v208, v4, 0
    v_dot2_f32_bf16 v22, v209, v5, v22
    v_dot2_f32_bf16 v22, v210, v6, v22
    v_dot2_f32_bf16 v22, v211, v7, v22
    v_add_u32 v233, 4, v233
    ds_write_b32 v38, v233 offset:128
    v_dot2_f32_bf16 v23, v212, v4, 0
    v_dot2_f32_bf16 v23, v213, v5, v23
    v_dot2_f32_bf16 v23, v214, v6, v23
    v_dot2_f32_bf16 v23, v215, v7, v23
    v_dot2_f32_bf16 v24, v216, v4, 0
    v_dot2_f32_bf16 v24, v217, v5, v24
    v_dot2_f32_bf16 v24, v218, v6, v24
    v_dot2_f32_bf16 v24, v219, v7, v24
    v_add_f32_dpp v28, v20, v20 row_ror:8 row_mask:0xf bank_mask:0x3
    v_add_f32_dpp v29, v21, v21 row_ror:8 row_mask:0xf bank_mask:0x3
    v_add_f32_dpp v28, v22, v22 row_ror:8 row_mask:0xf bank_mask:0xc
    v_add_f32_dpp v29, v23, v23 row_ror:8 row_mask:0xf bank_mask:0xc
    s_nop 0
    v_add_f32_dpp v32, v28, v28 row_half_mirror row_mask:0xf bank_mask:0x5
    v_add_f32_dpp v32, v29, v29 row_half_mirror row_mask:0xf bank_mask:0xa
    s_nop 1
    v_add_f32_dpp v32, v32, v32 quad_perm:[1,0,3,2] row_mask:0xf bank_mask:0xf
    s_nop 1
    v_add_f32_dpp v32, v32, v32 quad_perm:[2,3,0,1] row_mask:0xf bank_mask:0xf
    v_dot2_f32_bf16 v25, v220, v4, 0
    v_dot2_f32_bf16 v25, v221, v5, v25
    v_dot2_f32_bf16 v25, v222, v6, v25
    v_dot2_f32_bf16 v25, v223, v7, v25
    ds_read_b32 v234, v232
    v_dot2_f32_bf16 v26, v224, v4, 0
    v_dot2_f32_bf16 v26, v225, v5, v26
    v_dot2_f32_bf16 v26, v226, v6, v26
    v_dot2_f32_bf16 v26, v227, v7, v26
    v_add_u32 v233, 4, v233
    ds_write_b32 v38, v233 offset:128
    v_dot2_f32_bf16 v27, v228, v4, 0
    v_dot2_f32_bf16 v27, v229, v5, v27
    v_dot2_f32_bf16 v27, v230, v6, v27
    v_dot2_f32_bf16 v27, v231, v7, v27
    v_add_f32_dpp v28, v24, v24 row_ror:8 row_mask:0xf bank_mask:0x3
    v_add_f32_dpp v29, v25, v25 row_ror:8 row_mask:0xf bank_mask:0x3
    v_add_f32_dpp v28, v26, v26 row_ror:8 row_mask:0xf bank_mask:0xc
    v_add_f32_dpp v29, v27, v27 row_ror:8 row_mask:0xf bank_mask:0xc
    s_nop 0
    v_add_f32_dpp v33, v28, v28 row_half_mirror row_mask:0xf bank_mask:0x5
    v_add_f32_dpp v33, v29, v29 row_half_mirror row_mask:0xf bank_mask:0xa
    s_nop 1
    v_add_f32_dpp v33, v33, v33 quad_perm:[1,0,3,2] row_mask:0xf bank_mask:0xf
    s_nop 1
    v_add_f32_dpp v33, v33, v33 quad_perm:[2,3,0,1] row_mask:0xf bank_mask:0xf
    v_cndmask_b32 v34, v30, v31, s[50:51]
    v_cndmask_b32 v34, v34, v32, s[52:53]
    v_cndmask_b32 v34, v34, v33, s[54:55]
    v_cvt_pk_bf16_f32 v34, v34, v34
    v_and_b32 v34, 0xffff0000, v34
    v_mul_f32 v34, s56, v34
    v_cvt_pk_bf16_f32 v34, v34, v34
    v_and_b32 v34, 0xffff0000, v34
    v_max_f32 v35, v35, v34
    ds_write_b32 v2, v34
    v_add_u32 v2, 256, v2
    s_waitcnt vmcnt(4)
    s_or_b32 s48, s47, 98304
    buffer_load_dwordx4 v[80:83], v1, s[40:43], s48 offen nt
    v_dot2_f32_bf16 v20, v40, v4, 0
    v_dot2_f32_bf16 v20, v41, v5, v20
    v_dot2_f32_bf16 v20, v42, v6, v20
    v_dot2_f32_bf16 v20, v43, v7, v20
    v_dot2_f32_bf16 v21, v44, v4, 0
    v_dot2_f32_bf16 v21, v45, v5, v21
    v_dot2_f32_bf16 v21, v46, v6, v21
    v_dot2_f32_bf16 v21, v47, v7, v21
    v_dot2_f32_bf16 v22, v48, v4, 0
    v_dot2_f32_bf16 v22, v49, v5, v22
    v_dot2_f32_bf16 v22, v50, v6, v22
    v_dot2_f32_bf16 v22, v51, v7, v22
    v_add_u32 v233, 4, v233
    ds_write_b32 v38, v233 offset:128
    v_dot2_f32_bf16 v23, v52, v4, 0
    v_dot2_f32_bf16 v23, v53, v5, v23
    v_dot2_f32_bf16 v23, v54, v6, v23
    v_dot2_f32_bf16 v23, v55, v7, v23
    v_dot2_f32_bf16 v24, v56, v4, 0
    v_dot2_f32_bf16 v24, v57, v5, v24
    v_dot2_f32_bf16 v24, v58, v6, v24
    v_dot2_f32_bf16 v24, v59, v7, v24
    v_add_f32_dpp v28, v20, v20 row_ror:8 row_mask:0xf bank_mask:0x3
    v_add_f32_dpp v29, v21, v21 row_ror:8 row_mask:0xf bank_mask:0x3
    v_add_f32_dpp v28, v22, v22 row_ror:8 row_mask:0xf bank_mask:0xc
    v_add_f32_dpp v29, v23, v23 row_ror:8 row_mask:0xf bank_mask:0xc
    s_nop 0
    v_add_f32_dpp v30, v28, v28 row_half_mirror row_mask:0xf bank_mask:0x5
    v_add_f32_dpp v30, v29, v29 row_half_mirror row_mask:0xf bank_mask:0xa
    s_nop 1
    v_add_f32_dpp v30, v30, v30 quad_perm:[1,0,3,2] row_mask:0xf bank_mask:0xf
    s_nop 1
    v_add_f32_dpp v30, v30, v30 quad_perm:[2,3,0,1] row_mask:0xf bank_mask:0xf
    v_dot2_f32_bf16 v25, v60, v4, 0
    v_dot2_f32_bf16 v25, v61, v5, v25
    v_dot2_f32_bf16 v25, v62, v6, v25
    v_dot2_f32_bf16 v25, v63, v7, v25
    ds_read_b32 v234, v232
    s_waitcnt vmcnt(4)
    s_or_b32 s48, s47, 106496
    buffer_load_dwordx4 v[84:87], v1, s[40:43], s48 offen nt
    v_dot2_f32_bf16 v26, v64, v4, 0
    v_dot2_f32_bf16 v26, v65, v5, v26
    v_dot2_f32_bf16 v26, v66, v6, v26
    v_dot2_f32_bf16 v26, v67, v7, v26
    v_add_u32 v233, 4, v233
    ds_write_b32 v38, v233 offset:128
    s_waitcnt vmcnt(4)
    s_or_b32 s48, s47, 67584
    buffer_load_dwordx4 v[88:91], v1, s[40:43], s48 offen nt
    v_dot2_f32_bf16 v27, v68, v4, 0
    v_dot2_f32_bf16 v27, v69, v5, v27
    v_dot2_f32_bf16 v27, v70, v6, v27
    v_dot2_f32_bf16 v27, v71, v7, v27
    s_waitcnt vmcnt(4)
    s_or_b32 s48, s47, 75776
    buffer_load_dwordx4 v[92:95], v1, s[40:43], s48 offen nt
    v_dot2_f32_bf16 v20, v72, v4, 0
    v_dot2_f32_bf16 v20, v73, v5, v20
    v_dot2_f32_bf16 v20, v74, v6, v20
    v_dot2_f32_bf16 v20, v75, v7, v20
    v_add_f32_dpp v28, v24, v24 row_ror:8 row_mask:0xf bank_mask:0x3
    v_add_f32_dpp v29, v25, v25 row_ror:8 row_mask:0xf bank_mask:0x3
    v_add_f32_dpp v28, v26, v26 row_ror:8 row_mask:0xf bank_mask:0xc
    v_add_f32_dpp v29, v27, v27 row_ror:8 row_mask:0xf bank_mask:0xc
    s_nop 0
    v_add_f32_dpp v31, v28, v28 row_half_mirror row_mask:0xf bank_mask:0x5
    v_add_f32_dpp v31, v29, v29 row_half_mirror row_mask:0xf bank_mask:0xa
    s_nop 1
    v_add_f32_dpp v31, v31, v31 quad_perm:[1,0,3,2] row_mask:0xf bank_mask:0xf
    s_nop 1
    v_add_f32_dpp v31, v31, v31 quad_perm:[2,3,0,1] row_mask:0xf bank_mask:0xf
    s_waitcnt vmcnt(4)
    s_or_b32 s48, s47, 100352
    buffer_load_dwordx4 v[96:99], v1, s[40:43], s48 offen nt
    v_dot2_f32_bf16 v21, v76, v4, 0
    v_dot2_f32_bf16 v21, v77, v5, v21
    v_dot2_f32_bf16 v21, v78, v6, v21
    v_dot2_f32_bf16 v21, v79, v7, v21
    s_waitcnt vmcnt(4)
    s_or_b32 s48, s47, 108544
    buffer_load_dwordx4 v[100:103], v1, s[40:43], s48 offen nt
    v_dot2_f32_bf16 v22, v80, v4, 0
    v_dot2_f32_bf16 v22, v81, v5, v22
    v_dot2_f32_bf16 v22, v82, v6, v22
    v_dot2_f32_bf16 v22, v83, v7, v22
    v_add_u32 v233, 4, v233
    ds_write_b32 v38, v233 offset:128
    s_waitcnt vmcnt(4)
    s_or_b32 s47, s47, 0xffe1fbff
    s_add_u32 s47, s47, 1
    s_and_b32 s47, s47, 0x1e0400
    buffer_load_dwordx4 v[40:43], v1, s[40:43], s47 offen nt
    v_dot2_f32_bf16 v23, v84, v4, 0
    v_dot2_f32_bf16 v23, v85, v5, v23
    v_dot2_f32_bf16 v23, v86, v6, v23
    v_dot2_f32_bf16 v23, v87, v7, v23
    s_waitcnt vmcnt(4)
    s_or_b32 s48, s47, 8192
    buffer_load_dwordx4 v[44:47], v1, s[40:43], s48 offen nt
    v_dot2_f32_bf16 v24, v88, v4, 0
    v_dot2_f32_bf16 v24, v89, v5, v24
    v_dot2_f32_bf16 v24, v90, v6, v24
    v_dot2_f32_bf16 v24, v91, v7, v24
    v_add_f32_dpp v28, v20, v20 row_ror:8 row_mask:0xf bank_mask:0x3
    v_add_f32_dpp v29, v21, v21 row_ror:8 row_mask:0xf bank_mask:0x3
    v_add_f32_dpp v28, v22, v22 row_ror:8 row_mask:0xf bank_mask:0xc
    v_add_f32_dpp v29, v23, v23 row_ror:8 row_mask:0xf bank_mask:0xc
    s_nop 0
    v_add_f32_dpp v32, v28, v28 row_half_mirror row_mask:0xf bank_mask:0x5
    v_add_f32_dpp v32, v29, v29 row_half_mirror row_mask:0xf bank_mask:0xa
    s_nop 1
    v_add_f32_dpp v32, v32, v32 quad_perm:[1,0,3,2] row_mask:0xf bank_mask:0xf
    s_nop 1
    v_add_f32_dpp v32, v32, v32 quad_perm:[2,3,0,1] row_mask:0xf bank_mask:0xf
    s_waitcnt vmcnt(4)
    s_or_b32 s48, s47, 32768
    buffer_load_dwordx4 v[48:51], v1, s[40:43], s48 offen nt
    v_dot2_f32_bf16 v25, v92, v4, 0
    v_dot2_f32_bf16 v25, v93, v5, v25
    v_dot2_f32_bf16 v25, v94, v6, v25
    v_dot2_f32_bf16 v25, v95, v7, v25
    ds_read_b32 v234, v232
    s_waitcnt vmcnt(4)
    s_or_b32 s48, s47, 40960
    buffer_load_dwordx4 v[52:55], v1, s[40:43], s48 offen nt
    v_dot2_f32_bf16 v26, v96, v4, 0
    v_dot2_f32_bf16 v26, v97, v5, v26
    v_dot2_f32_bf16 v26, v98, v6, v26
    v_dot2_f32_bf16 v26, v99, v7, v26
    v_add_u32 v233, 4, v233
    ds_write_b32 v38, v233 offset:128
    s_waitcnt vmcnt(4)
    s_or_b32 s48, s47, 2048
    buffer_load_dwordx4 v[56:59], v1, s[40:43], s48 offen nt
    v_dot2_f32_bf16 v27, v100, v4, 0
    v_dot2_f32_bf16 v27, v101, v5, v27
    v_dot2_f32_bf16 v27, v102, v6, v27
    v_dot2_f32_bf16 v27, v103, v7, v27
    v_add_f32_dpp v28, v24, v24 row_ror:8 row_mask:0xf bank_mask:0x3
    v_add_f32_dpp v29, v25, v25 row_ror:8 row_mask:0xf bank_mask:0x3
    v_add_f32_dpp v28, v26, v26 row_ror:8 row_mask:0xf bank_mask:0xc
    v_add_f32_dpp v29, v27, v27 row_ror:8 row_mask:0xf bank_mask:0xc
    s_nop 0
    v_add_f32_dpp v33, v28, v28 row_half_mirror row_mask:0xf bank_mask:0x5
    v_add_f32_dpp v33, v29, v29 row_half_mirror row_mask:0xf bank_mask:0xa
    s_nop 1
    v_add_f32_dpp v33, v33, v33 quad_perm:[1,0,3,2] row_mask:0xf bank_mask:0xf
    s_nop 1
    v_add_f32_dpp v33, v33, v33 quad_perm:[2,3,0,1] row_mask:0xf bank_mask:0xf
    v_cndmask_b32 v34, v30, v31, s[50:51]
    v_cndmask_b32 v34, v34, v32, s[52:53]
    v_cndmask_b32 v34, v34, v33, s[54:55]
    v_cvt_pk_bf16_f32 v34, v34, v34
    v_and_b32 v34, 0xffff0000, v34
    v_mul_f32 v34, s56, v34
    v_cvt_pk_bf16_f32 v34, v34, v34
    v_and_b32 v34, 0xffff0000, v34
    v_max_f32 v35, v35, v34
    ds_write_b32 v2, v34
    v_add_u32 v2, 256, v2
    s_mov_b32 s49, 29
.p2align 3
L_k5_0:
    s_waitcnt vmcnt(4)
    s_or_b32 s48, s47, 10240
    buffer_load_dwordx4 v[60:63], v1, s[40:43], s48 offen nt
    v_dot2_f32_bf16 v20, v40, v4, 0
    v_dot2_f32_bf16 v20, v41, v5, v20
    v_dot2_f32_bf16 v20, v42, v6, v20
    v_dot2_f32_bf16 v20, v43, v7, v20
L_k5_1:
    s_waitcnt vmcnt(4)
    s_or_b32 s48, s47, 34816
    buffer_load_dwordx4 v[64:67], v1, s[40:43], s48 offen nt
    v_dot2_f32_bf16 v21, v44, v4, 0
    v_dot2_f32_bf16 v21, v45, v5, v21
    v_dot2_f32_bf16 v21, v46, v6, v21
    v_dot2_f32_bf16 v21, v47, v7, v21
    s_waitcnt vmcnt(4)
    s_or_b32 s48, s47, 43008
    buffer_load_dwordx4 v[68:71], v1, s[40:43], s48 offen nt
    v_dot2_f32_bf16 v22, v48, v4, 0
    v_dot2_f32_bf16 v22, v49, v5, v22
    v_dot2_f32_bf16 v22, v50, v6, v22
    v_dot2_f32_bf16 v22, v51, v7, v22
    v_add_u32 v233, 4, v233
    ds_write_b32 v38, v233 offset:128
    s_waitcnt vmcnt(4)
    s_or_b32 s48, s47, 65536
    buffer_load_dwordx4 v[72:75], v1, s[40:43], s48 offen nt
    v_dot2_f32_bf16 v23, v52, v4, 0
    v_dot2_f32_bf16 v23, v53, v5, v23
    v_dot2_f32_bf16 v23, v54, v6, v23
    v_dot2_f32_bf16 v23, v55, v7, v23
    s_waitcnt vmcnt(4)
    s_or_b32 s48, s47, 73728
    buffer_load_dwordx4 v[76:79], v1, s[40:43], s48 offen nt
    v_dot2_f32_bf16 v24, v56, v4, 0
    v_dot2_f32_bf16 v24, v57, v5, v24
    v_dot2_f32_bf16 v24, v58, v6, v24
    v_dot2_f32_bf16 v24, v59, v7, v24
    v_add_f32_dpp v28, v20, v20 row_ror:8 row_mask:0xf bank_mask:0x3
    v_add_f32_dpp v29, v21, v21 row_ror:8 row_mask:0xf bank_mask:0x3
    v_add_f32_dpp v28, v22, v22 row_ror:8 row_mask:0xf bank_mask:0xc
    v_add_f32_dpp v29, v23, v23 row_ror:8 row_mask:0xf bank_mask:0xc
    s_nop 0
    v_add_f32_dpp v30, v28, v28 row_half_mirror row_mask:0xf bank_mask:0x5
    v_add_f32_dpp v30, v29, v29 row_half_mirror row_mask:0xf bank_mask:0xa
    s_nop 1
    v_add_f32_dpp v30, v30, v30 quad_perm:[1,0,3,2] row_mask:0xf bank_mask:0xf
    s_nop 1
    v_add_f32_dpp v30, v30, v30 quad_perm:[2,3,0,1] row_mask:0xf bank_mask:0xf
    s_waitcnt vmcnt(4)
    s_or_b32 s48, s47, 98304
    buffer_load_dwordx4 v[80:83], v1, s[40:43], s48 offen nt
    v_dot2_f32_bf16 v25, v60, v4, 0
    v_dot2_f32_bf16 v25, v61, v5, v25
    v_dot2_f32_bf16 v25, v62, v6, v25
    v_dot2_f32_bf16 v25, v63, v7, v25
    ds_read_b32 v234, v232
    s_waitcnt vmcnt(4)
    s_or_b32 s48, s47, 106496
    buffer_load_dwordx4 v[84:87], v1, s[40:43], s48 offen nt
    v_dot2_f32_bf16 v26, v64, v4, 0
    v_dot2_f32_bf16 v26, v65, v5, v26
    v_dot2_f32_bf16 v26, v66, v6, v26
    v_dot2_f32_bf16 v26, v67, v7, v26
    v_add_u32 v233, 4, v233
    ds_write_b32 v38, v233 offset:128
    s_waitcnt vmcnt(4)
    s_or_b32 s48, s47, 67584
    buffer_load_dwordx4 v[88:91], v1, s[40:43], s48 offen nt
    v_dot2_f32_bf16 v27, v68, v4, 0
    v_dot2_f32_bf16 v27, v69, v5, v27
    v_dot2_f32_bf16 v27, v70, v6, v27
    v_dot2_f32_bf16 v27, v71, v7, v27
    s_waitcnt lgkmcnt(0)
    v_readfirstlane_b32 s59, v234
    s_cmp_lg_u32 s59, 5
    s_cbranch_scc1 L_k5_x
    s_waitcnt vmcnt(4)
    s_or_b32 s48, s47, 75776
    buffer_load_dwordx4 v[92:95], v1, s[40:43], s48 offen nt
    v_dot2_f32_bf16 v20, v72, v4, 0
    v_dot2_f32_bf16 v20, v73, v5, v20
    v_dot2_f32_bf16 v20, v74, v6, v20
    v_dot2_f32_bf16 v20, v75, v7, v20
    v_add_f32_dpp v28, v24, v24 row_ror:8 row_mask:0xf bank_mask:0x3
    v_add_f32_dpp v29, v25, v25 row_ror:8 row_mask:0xf bank_mask:0x3
    v_add_f32_dpp v28, v26, v26 row_ror:8 row_mask:0xf bank_mask:0xc
    v_add_f32_dpp v29, v27, v27 row_ror:8 row_mask:0xf bank_mask:0xc
    s_nop 0
    v_add_f32_dpp v31, v28, v28 row_half_mirror row_mask:0xf bank_mask:0x5
    v_add_f32_dpp v31, v29, v29 row_half_mirror row_mask:0xf bank_mask:0xa
    s_nop 1
    v_add_f32_dpp v31, v31, v31 quad_perm:[1,0,3,2] row_mask:0xf bank_mask:0xf
    s_nop 1
    v_add_f32_dpp v31, v31, v31 quad_perm:[2,3,0,1] row_mask:0xf bank_mask:0xf
L_k5_9:
    s_waitcnt vmcnt(4)
    s_or_b32 s48, s47, 100352
    buffer_load_dwordx4 v[96:99], v1, s[40:43], s48 offen nt
    v_dot2_f32_bf16 v21, v76, v4, 0
    v_dot2_f32_bf16 v21, v77, v5, v21
    v_dot2_f32_bf16 v21, v78, v6, v21
    v_dot2_f32_bf16 v21, v79, v7, v21
    s_waitcnt vmcnt(4)
    s_or_b32 s48, s47, 108544
    buffer_load_dwordx4 v[100:103], v1, s[40:43], s48 offen nt
    v_dot2_f32_bf16 v22, v80, v4, 0
    v_dot2_f32_bf16 v22, v81, v5, v22
    v_dot2_f32_bf16 v22, v82, v6, v22
    v_dot2_f32_bf16 v22, v83, v7, v22
    v_add_u32 v233, 4, v233
    ds_write_b32 v38, v233 offset:128
    s_cmp_eq_u32 s49, 1
    s_cselect_b32 s40, s44, s40
    s_cselect_b32 s41, s45, s41
    s_waitcnt vmcnt(4)
    s_or_b32 s47, s47, 0xffe1fbff
    s_add_u32 s47, s47, 1
    s_and_b32 s47, s47, 0x1e0400
    buffer_load_dwordx4 v[40:43], v1, s[40:43], s47 offen nt
    v_dot2_f32_bf16 v23, v84, v4, 0
    v_dot2_f32_bf16 v23, v85, v5, v23
    v_dot2_f32_bf16 v23, v86, v6, v23
    v_dot2_f32_bf16 v23, v87, v7, v23
    s_waitcnt vmcnt(4)
    s_or_b32 s48, s47, 8192
    buffer_load_dwordx4 v[44:47], v1, s[40:43], s48 offen nt
    v_dot2_f32_bf16 v24, v88, v4, 0
    v_dot2_f32_bf16 v24, v89, v5, v24
    v_dot2_f32_bf16 v24, v90, v6, v24
    v_dot2_f32_bf16 v24, v91, v7, v24
    v_add_f32_dpp v28, v20, v20 row_ror:8 row_mask:0xf bank_mask:0x3
    v_add_f32_dpp v29, v21, v21 row_ror:8 row_mask:0xf bank_mask:0x3
    v_add_f32_dpp v28, v22, v22 row_ror:8 row_mask:0xf bank_mask:0xc
    v_add_f32_dpp v29, v23, v23 row_ror:8 row_mask:0xf bank_mask:0xc
    s_nop 0
    v_add_f32_dpp v32, v28, v28 row_half_mirror row_mask:0xf bank_mask:0x5
    v_add_f32_dpp v32, v29, v29 row_half_mirror row_mask:0xf bank_mask:0xa
    s_nop 1
    v_add_f32_dpp v32, v32, v32 quad_perm:[1,0,3,2] row_mask:0xf bank_mask:0xf
    s_nop 1
    v_add_f32_dpp v32, v32, v32 quad_perm:[2,3,0,1] row_mask:0xf bank_mask:0xf
    s_waitcnt vmcnt(4)
    s_or_b32 s48, s47, 32768
    buffer_load_dwordx4 v[48:51], v1, s[40:43], s48 offen nt
    v_dot2_f32_bf16 v25, v92, v4, 0
    v_dot2_f32_bf16 v25, v93, v5, v25
    v_dot2_f32_bf16 v25, v94, v6, v25
    v_dot2_f32_bf16 v25, v95, v7, v25
    ds_read_b32 v234, v232
    s_waitcnt vmcnt(4)
    s_or_b32 s48, s47, 40960
    buffer_load_dwordx4 v[52:55], v1, s[40:43], s48 offen nt
    v_dot2_f32_bf16 v26, v96, v4, 0
    v_dot2_f32_bf16 v26, v97, v5, v26
    v_dot2_f32_bf16 v26, v98, v6, v26
    v_dot2_f32_bf16 v26, v99, v7, v26
    v_add_u32 v233, 4, v233
    ds_write_b32 v38, v233 offset:128
    s_waitcnt vmcnt(4)
    s_or_b32 s48, s47, 2048
    buffer_load_dwordx4 v[56:59], v1, s[40:43], s48 offen nt
    v_dot2_f32_bf16 v27, v100, v4, 0
    v_dot2_f32_bf16 v27, v101, v5, v27
    v_dot2_f32_bf16 v27, v102, v6, v27
    v_dot2_f32_bf16 v27, v103, v7, v27
    v_add_f32_dpp v28, v24, v24 row_ror:8 row_mask:0xf bank_mask:0x3
    v_add_f32_dpp v29, v25, v25 row_ror:8 row_mask:0xf bank_mask:0x3
    v_add_f32_dpp v28, v26, v26 row_ror:8 row_mask:0xf bank_mask:0xc
    v_add_f32_dpp v29, v27, v27 row_ror:8 row_mask:0xf bank_mask:0xc
    s_nop 0
    v_add_f32_dpp v33, v28, v28 row_half_mirror row_mask:0xf bank_mask:0x5
    v_add_f32_dpp v33, v29, v29 row_half_mirror row_mask:0xf bank_mask:0xa
    s_nop 1
    v_add_f32_dpp v33, v33, v33 quad_perm:[1,0,3,2] row_mask:0xf bank_mask:0xf
    s_nop 1
    v_add_f32_dpp v33, v33, v33 quad_perm:[2,3,0,1] row_mask:0xf bank_mask:0xf
    v_cndmask_b32 v34, v30, v31, s[50:51]
    v_cndmask_b32 v34, v34, v32, s[52:53]
    v_cndmask_b32 v34, v34, v33, s[54:55]
    v_cvt_pk_bf16_f32 v34, v34, v34
    v_and_b32 v34, 0xffff0000, v34
    v_mul_f32 v34, s56, v34
    v_cvt_pk_bf16_f32 v34, v34, v34
    v_and_b32 v34, 0xffff0000, v34
    v_max_f32 v35, v35, v34
    ds_write_b32 v2, v34
    v_add_u32 v2, 256, v2
    s_sub_u32 s49, s49, 1
    s_cmp_eq_u32 s49, 0
    s_cbranch_scc1 L_kx5
    s_waitcnt lgkmcnt(0)
    v_readfirstlane_b32 s59, v234
    s_cmp_eq_u32 s59, 5
    s_cbranch_scc1 L_k5_0
    s_or_b32 s48, s47, 10240
    buffer_load_dwordx4 v[60:63], v1, s[40:43], s48 offen nt
    s_branch L_k6_0
L_k5_x:
    s_or_b32 s48, s47, 75776
    buffer_load_dwordx4 v[92:95], v1, s[40:43], s48 offen nt
    s_branch L_k6_8
.p2align 3
L_k6_0:
    s_waitcnt vmcnt(5)
    s_or_b32 s48, s47, 34816
    buffer_load_dwordx4 v[64:67], v1, s[40:43], s48 offen nt
    v_dot2_f32_bf16 v20, v40, v4, 0
    v_dot2_f32_bf16 v20, v41, v5, v20
    v_dot2_f32_bf16 v20, v42, v6, v20
    v_dot2_f32_bf16 v20, v43, v7, v20
    s_waitcnt vmcnt(5)
    s_or_b32 s48, s47, 43008
    buffer_load_dwordx4 v[68:71], v1, s[40:43], s48 offen nt
    v_dot2_f32_bf16 v21, v44, v4, 0
    v_dot2_f32_bf16 v21, v45, v5, v21
    v_dot2_f32_bf16 v21, v46, v6, v21
    v_dot2_f32_bf16 v21, v47, v7, v21
    s_waitcnt vmcnt(5)
    s_or_b32 s48, s47, 65536
    buffer_load_dwordx4 v[72:75], v1, s[40:43], s48 offen nt
    v_dot2_f32_bf16 v22, v48, v4, 0
    v_dot2_f32_bf16 v22, v49, v5, v22
    v_dot2_f32_bf16 v22, v50, v6, v22
    v_dot2_f32_bf16 v22, v51, v7, v22
    v_add_u32 v233, 4, v233
    ds_write_b32 v38, v233 offset:128
    s_waitcnt vmcnt(5)
    s_or_b32 s48, s47, 73728
    buffer_load_dwordx4 v[76:79], v1, s[40:43], s48 offen nt
    v_dot2_f32_bf16 v23, v52, v4, 0
    v_dot2_f32_bf16 v23, v53, v5, v23
    v_dot2_f32_bf16 v23, v54, v6, v23
    v_dot2_f32_bf16 v23, v55, v7, v23
    s_waitcnt vmcnt(5)
    s_or_b32 s48, s47, 98304
    buffer_load_dwordx4 v[80:83], v1, s[40:43], s48 offen nt
    v_dot2_f32_bf16 v24, v56, v4, 0
    v_dot2_f32_bf16 v24, v57, v5, v24
    v_dot2_f32_bf16 v24, v58, v6, v24
    v_dot2_f32_bf16 v24, v59, v7, v24
    v_add_f32_dpp v28, v20, v20 row_ror:8 row_mask:0xf bank_mask:0x3
    v_add_f32_dpp v29, v21, v21 row_ror:8 row_mask:0xf bank_mask:0x3
    v_add_f32_dpp v28, v22, v22 row_ror:8 row_mask:0xf bank_mask:0xc
    v_add_f32_dpp v29, v23, v23 row_ror:8 row_mask:0xf bank_mask:0xc
    s_nop 0
    v_add_f32_dpp v30, v28, v28 row_half_mirror row_mask:0xf bank_mask:0x5
    v_add_f32_dpp v30, v29, v29 row_half_mirror row_mask:0xf bank_mask:0xa
    s_nop 1
    v_add_f32_dpp v30, v30, v30 quad_perm:[1,0,3,2] row_mask:0xf bank_mask:0xf
    s_nop 1
    v_add_f32_dpp v30, v30, v30 quad_perm:[2,3,0,1] row_mask:0xf bank_mask:0xf
    s_waitcnt vmcnt(5)
    s_or_b32 s48, s47, 106496
    buffer_load_dwordx4 v[84:87], v1, s[40:43], s48 offen nt
    v_dot2_f32_bf16 v25, v60, v4, 0
    v_dot2_f32_bf16 v25, v61, v5, v25
    v_dot2_f32_bf16 v25, v62, v6, v25
    v_dot2_f32_bf16 v25, v63, v7, v25
    ds_read_b32 v234, v232
    s_waitcnt vmcnt(5)
    s_or_b32 s48, s47, 67584
    buffer_load_dwordx4 v[88:91], v1, s[40:43], s48 offen nt
    v_dot2_f32_bf16 v26, v64, v4, 0
    v_dot2_f32_bf16 v26, v65, v5, v26
    v_dot2_f32_bf16 v26, v66, v6, v26
    v_dot2_f32_bf16 v26, v67, v7, v26
    v_add_u32 v233, 4, v233
    ds_write_b32 v38, v233 offset:128
    s_waitcnt vmcnt(5)
    s_or_b32 s48, s47, 75776
    buffer_load_dwordx4 v[92:95], v1, s[40:43], s48 offen nt
    v_dot2_f32_bf16 v27, v68, v4, 0
    v_dot2_f32_bf16 v27, v69, v5, v27
    v_dot2_f32_bf16 v27, v70, v6, v27
    v_dot2_f32_bf16 v27, v71, v7, v27
    s_waitcnt lgkmcnt(0)
    v_readfirstlane_b32 s59, v234
    s_cmp_lg_u32 s59, 6
    s_cbranch_scc1 L_k6_x
L_k6_8:
    s_waitcnt vmcnt(5)
    s_or_b32 s48, s47, 100352
    buffer_load_dwordx4 v[96:99], v1, s[40:43], s48 offen nt
    v_dot2_f32_bf16 v20, v72, v4, 0
    v_dot2_f32_bf16 v20, v73, v5, v20
    v_dot2_f32_bf16 v20, v74, v6, v20
    v_dot2_f32_bf16 v20, v75, v7, v20
    v_add_f32_dpp v28, v24, v24 row_ror:8 row_mask:0xf bank_mask:0x3
    v_add_f32_dpp v29, v25, v25 row_ror:8 row_mask:0xf bank_mask:0x3
    v_add_f32_dpp v28, v26, v26 row_ror:8 row_mask:0xf bank_mask:0xc
    v_add_f32_dpp v29, v27, v27 row_ror:8 row_mask:0xf bank_mask:0xc
    s_nop 0
    v_add_f32_dpp v31, v28, v28 row_half_mirror row_mask:0xf bank_mask:0x5
    v_add_f32_dpp v31, v29, v29 row_half_mirror row_mask:0xf bank_mask:0xa
    s_nop 1
    v_add_f32_dpp v31, v31, v31 quad_perm:[1,0,3,2] row_mask:0xf bank_mask:0xf
    s_nop 1
    v_add_f32_dpp v31, v31, v31 quad_perm:[2,3,0,1] row_mask:0xf bank_mask:0xf
    s_waitcnt vmcnt(5)
    s_or_b32 s48, s47, 108544
    buffer_load_dwordx4 v[100:103], v1, s[40:43], s48 offen nt
    v_dot2_f32_bf16 v21, v76, v4, 0
    v_dot2_f32_bf16 v21, v77, v5, v21
    v_dot2_f32_bf16 v21, v78, v6, v21
    v_dot2_f32_bf16 v21, v79, v7, v21
    s_cmp_eq_u32 s49, 1
    s_cselect_b32 s40, s44, s40
    s_cselect_b32 s41, s45, s41
    s_waitcnt vmcnt(5)
    s_or_b32 s47, s47, 0xffe1fbff
    s_add_u32 s47, s47, 1
    s_and_b32 s47, s47, 0x1e0400
    buffer_load_dwordx4 v[40:43], v1, s[40:43], s47 offen nt
    v_dot2_f32_bf16 v22, v80, v4, 0
    v_dot2_f32_bf16 v22, v81, v5, v22
    v_dot2_f32_bf16 v22, v82, v6, v22
    v_dot2_f32_bf16 v22, v83, v7, v22
    v_add_u32 v233, 4, v233
    ds_write_b32 v38, v233 offset:128
    s_waitcnt vmcnt(5)
    s_or_b32 s48, s47, 8192
    buffer_load_dwordx4 v[44:47], v1, s[40:43], s48 offen nt
    v_dot2_f32_bf16 v23, v84, v4, 0
    v_dot2_f32_bf16 v23, v85, v5, v23
    v_dot2_f32_bf16 v23, v86, v6, v23
    v_dot2_f32_bf16 v23, v87, v7, v23
    s_waitcnt vmcnt(5)
    s_or_b32 s48, s47, 32768
    buffer_load_dwordx4 v[48:51], v1, s[40:43], s48 offen nt
    v_dot2_f32_bf16 v24, v88, v4, 0
    v_dot2_f32_bf16 v24, v89, v5, v24
    v_dot2_f32_bf16 v24, v90, v6, v24
    v_dot2_f32_bf16 v24, v91, v7, v24
    v_add_f32_dpp v28, v20, v20 row_ror:8 row_mask:0xf bank_mask:0x3
    v_add_f32_dpp v29, v21, v21 row_ror:8 row_mask:0xf bank_mask:0x3
    v_add_f32_dpp v28, v22, v22 row_ror:8 row_mask:0xf bank_mask:0xc
    v_add_f32_dpp v29, v23, v23 row_ror:8 row_mask:0xf bank_mask:0xc
    s_nop 0
    v_add_f32_dpp v32, v28, v28 row_half_mirror row_mask:0xf bank_mask:0x5
    v_add_f32_dpp v32, v29, v29 row_half_mirror row_mask:0xf bank_mask:0xa
    s_nop 1
    v_add_f32_dpp v32, v32, v32 quad_perm:[1,0,3,2] row_mask:0xf bank_mask:0xf
    s_nop 1
    v_add_f32_dpp v32, v32, v32 quad_perm:[2,3,0,1] row_mask:0xf bank_mask:0xf
    s_waitcnt vmcnt(5)
    s_or_b32 s48, s47, 40960
    buffer_load_dwordx4 v[52:55], v1, s[40:43], s48 offen nt
    v_dot2_f32_bf16 v25, v92, v4, 0
    v_dot2_f32_bf16 v25, v93, v5, v25
    v_dot2_f32_bf16 v25, v94, v6, v25
    v_dot2_f32_bf16 v25, v95, v7, v25
    ds_read_b32 v234, v232
    s_waitcnt vmcnt(5)
    s_or_b32 s48, s47, 2048
    buffer_load_dwordx4 v[56:59], v1, s[40:43], s48 offen nt
    v_dot2_f32_bf16 v26, v96, v4, 0
    v_dot2_f32_bf16 v26, v97, v5, v26
    v_dot2_f32_bf16 v26, v98, v6, v26
    v_dot2_f32_bf16 v26, v99, v7, v26
    v_add_u32 v233, 4, v233
    ds_write_b32 v38, v233 offset:128
    s_waitcnt vmcnt(5)
    s_or_b32 s48, s47, 10240
    buffer_load_dwordx4 v[60:63], v1, s[40:43], s48 offen nt
    v_dot2_f32_bf16 v27, v100, v4, 0
    v_dot2_f32_bf16 v27, v101, v5, v27
    v_dot2_f32_bf16 v27, v102, v6, v27
    v_dot2_f32_bf16 v27, v103, v7, v27
    v_add_f32_dpp v28, v24, v24 row_ror:8 row_mask:0xf bank_mask:0x3
    v_add_f32_dpp v29, v25, v25 row_ror:8 row_mask:0xf bank_mask:0x3
    v_add_f32_dpp v28, v26, v26 row_ror:8 row_mask:0xf bank_mask:0xc
    v_add_f32_dpp v29, v27, v27 row_ror:8 row_mask:0xf bank_mask:0xc
    s_nop 0
    v_add_f32_dpp v33, v28, v28 row_half_mirror row_mask:0xf bank_mask:0x5
    v_add_f32_dpp v33, v29, v29 row_half_mirror row_mask:0xf bank_mask:0xa
    s_nop 1
    v_add_f32_dpp v33, v33, v33 quad_perm:[1,0,3,2] row_mask:0xf bank_mask:0xf
    s_nop 1
    v_add_f32_dpp v33, v33, v33 quad_perm:[2,3,0,1] row_mask:0xf bank_mask:0xf
    v_cndmask_b32 v34, v30, v31, s[50:51]
    v_cndmask_b32 v34, v34, v32, s[52:53]
    v_cndmask_b32 v34, v34, v33, s[54:55]
    v_cvt_pk_bf16_f32 v34, v34, v34
    v_and_b32 v34, 0xffff0000, v34
    v_mul_f32 v34, s56, v34
    v_cvt_pk_bf16_f32 v34, v34, v34
    v_and_b32 v34, 0xffff0000, v34
    v_max_f32 v35, v35, v34
    ds_write_b32 v2, v34
    v_add_u32 v2, 256, v2
    s_sub_u32 s49, s49, 1
    s_cmp_eq_u32 s49, 0
    s_cbranch_scc1 L_kx6
    s_waitcnt lgkmcnt(0)
    v_readfirstlane_b32 s59, v234
    s_cmp_eq_u32 s59, 6
    s_cbranch_scc1 L_k6_0
    s_waitcnt vmcnt(5)
    v_dot2_f32_bf16 v20, v40, v4, 0
    v_dot2_f32_bf16 v20, v41, v5, v20
    v_dot2_f32_bf16 v20, v42, v6, v20
    v_dot2_f32_bf16 v20, v43, v7, v20
    s_branch L_k5_1
L_k6_x:
    s_waitcnt vmcnt(5)
    v_dot2_f32_bf16 v20, v72, v4, 0
    v_dot2_f32_bf16 v20, v73, v5, v20
    v_dot2_f32_bf16 v20, v74, v6, v20
    v_dot2_f32_bf16 v20, v75, v7, v20
    v_add_f32_dpp v28, v24, v24 row_ror:8 row_mask:0xf bank_mask:0x3
    v_add_f32_dpp v29, v25, v25 row_ror:8 row_mask:0xf bank_mask:0x3
    v_add_f32_dpp v28, v26, v26 row_ror:8 row_mask:0xf bank_mask:0xc
    v_add_f32_dpp v29, v27, v27 row_ror:8 row_mask:0xf bank_mask:0xc
    s_nop 0
    v_add_f32_dpp v31, v28, v28 row_half_mirror row_mask:0xf bank_mask:0x5
    v_add_f32_dpp v31, v29, v29 row_half_mirror row_mask:0xf bank_mask:0xa
    s_nop 1
    v_add_f32_dpp v31, v31, v31 quad_perm:[1,0,3,2] row_mask:0xf bank_mask:0xf
    s_nop 1
    v_add_f32_dpp v31, v31, v31 quad_perm:[2,3,0,1] row_mask:0xf bank_mask:0xf
    s_branch L_k5_9
L_kx5:
    s_mov_b32 s59, 5
    s_branch L_kdone
L_kx6:
    s_mov_b32 s59, 6
L_kdone:
    s_lshl_b32 s5, s3, 13
    v_lshl_add_u32 v2, v0, 2, s5
    ds_read_b32 v37, v2
    v_max_f32_dpp v35, v35, v35 quad_perm:[1,0,3,2] row_mask:0xf bank_mask:0xf
    s_nop 1
    v_max_f32_dpp v35, v35, v35 quad_perm:[2,3,0,1] row_mask:0xf bank_mask:0xf
    s_nop 1
    v_max_f32_dpp v35, v35, v35 row_half_mirror row_mask:0xf bank_mask:0xf
    s_nop 1
    v_max_f32_dpp v35, v35, v35 row_mirror row_mask:0xf bank_mask:0xf
    v_mov_b32 v3, v35
    s_nop 1
    v_permlane16_swap_b32 v35, v3
    v_max_f32 v35, v35, v3
    v_mov_b32 v3, v35
    s_nop 1
    v_permlane32_swap_b32 v35, v3
    v_max_f32 v35, v35, v3
    v_mul_f32 v35, s57, v35
    ds_write_b32 v38, v35
    v_mov_b32 v16, 0
    v_mov_b32 v17, 0
    v_mov_b32 v18, 0
    v_mov_b32 v19, 0
    s_mov_b32 s49, 32
    v_lshrrev_b32 v39, 4, v0
    v_lshlrev_b32 v39, 4, v39
    v_and_b32 v21, 15, v0
    v_lshl_add_u32 v39, v21, 5, v39
    s_lshl_b32 s5, s3, 9
    v_add_u32 v39, s5, v39
    v_lshlrev_b32 v21, 4, v0
    s_lshl_b32 s5, s4, 9
    s_add_u32 s5, s5, 8192
    v_mov_b32 v22, 35152
    v_mov_b32 v23, 1
    s_cmp_eq_u32 s59, 6
    s_cbranch_scc1 L_v6_0
.p2align 3
L_v5_0:
    s_waitcnt lgkmcnt(0)
    v_fma_f32 v36, v37, s57, -v35
    ds_read_b32 v37, v2 offset:256
    v_add_u32 v2, 256, v2
    v_exp_f32 v36, v36
    s_nop 0
    v_cvt_pk_bf16_f32 v36, v36, v36
    s_nop 1
    v_and_b32_dpp v12, v36, v8 row_newbcast:0 row_mask:0xf bank_mask:0xf
    v_and_b32_dpp v13, v36, v9 row_newbcast:0 row_mask:0xf bank_mask:0xf
    v_and_b32_dpp v14, v36, v10 row_newbcast:0 row_mask:0xf bank_mask:0xf
    v_and_b32_dpp v15, v36, v11 row_newbcast:0 row_mask:0xf bank_mask:0xf
    s_waitcnt vmcnt(4)
    s_or_b32 s48, s47, 10240
    buffer_load_dwordx4 v[60:63], v1, s[40:43], s48 offen nt
    v_mfma_f32_16x16x32_bf16 v[16:19], v[12:15], v[40:43], v[16:19]
L_v5_1:
    v_and_b32_dpp v12, v36, v8 row_newbcast:4 row_mask:0xf bank_mask:0xf
    v_and_b32_dpp v13, v36, v9 row_newbcast:4 row_mask:0xf bank_mask:0xf
    v_and_b32_dpp v14, v36, v10 row_newbcast:4 row_mask:0xf bank_mask:0xf
    v_and_b32_dpp v15, v36, v11 row_newbcast:4 row_mask:0xf bank_mask:0xf
    s_waitcnt vmcnt(4)
    s_or_b32 s48, s47, 34816
    buffer_load_dwordx4 v[64:67], v1, s[40:43], s48 offen nt
    v_mfma_f32_16x16x32_bf16 v[16:19], v[12:15], v[44:47], v[16:19]
    v_and_b32_dpp v12, v36, v8 row_newbcast:8 row_mask:0xf bank_mask:0xf
    v_and_b32_dpp v13, v36, v9 row_newbcast:8 row_mask:0xf bank_mask:0xf
    v_and_b32_dpp v14, v36, v10 row_newbcast:8 row_mask:0xf bank_mask:0xf
    v_and_b32_dpp v15, v36, v11 row_newbcast:8 row_mask:0xf bank_mask:0xf
    s_waitcnt vmcnt(4)
    s_or_b32 s48, s47, 43008
    buffer_load_dwordx4 v[68:71], v1, s[40:43], s48 offen nt
    v_mfma_f32_16x16x32_bf16 v[16:19], v[12:15], v[48:51], v[16:19]
    v_add_u32 v233, 4, v233
    ds_write_b32 v38, v233 offset:128
    v_and_b32_dpp v12, v36, v8 row_newbcast:12 row_mask:0xf bank_mask:0xf
    v_and_b32_dpp v13, v36, v9 row_newbcast:12 row_mask:0xf bank_mask:0xf
    v_and_b32_dpp v14, v36, v10 row_newbcast:12 row_mask:0xf bank_mask:0xf
    v_and_b32_dpp v15, v36, v11 row_newbcast:12 row_mask:0xf bank_mask:0xf
    s_waitcnt vmcnt(4)
    s_or_b32 s48, s47, 65536
    buffer_load_dwordx4 v[72:75], v1, s[40:43], s48 offen nt
    v_mfma_f32_16x16x32_bf16 v[16:19], v[12:15], v[52:55], v[16:19]
    v_and_b32_dpp v12, v36, v8 row_newbcast:1 row_mask:0xf bank_mask:0xf
    v_and_b32_dpp v13, v36, v9 row_newbcast:1 row_mask:0xf bank_mask:0xf
    v_and_b32_dpp v14, v36, v10 row_newbcast:1 row_mask:0xf bank_mask:0xf
    v_and_b32_dpp v15, v36, v11 row_newbcast:1 row_mask:0xf bank_mask:0xf
    s_waitcnt vmcnt(4)
    s_or_b32 s48, s47, 73728
    buffer_load_dwordx4 v[76:79], v1, s[40:43], s48 offen nt
    v_mfma_f32_16x16x32_bf16 v[16:19], v[12:15], v[56:59], v[16:19]
    v_and_b32_dpp v12, v36, v8 row_newbcast:5 row_mask:0xf bank_mask:0xf
    v_and_b32_dpp v13, v36, v9 row_newbcast:5 row_mask:0xf bank_mask:0xf
    v_and_b32_dpp v14, v36, v10 row_newbcast:5 row_mask:0xf bank_mask:0xf
    v_and_b32_dpp v15, v36, v11 row_newbcast:5 row_mask:0xf bank_mask:0xf
    s_waitcnt vmcnt(4)
    s_or_b32 s48, s47, 98304
    buffer_load_dwordx4 v[80:83], v1, s[40:43], s48 offen nt
    v_mfma_f32_16x16x32_bf16 v[16:19], v[12:15], v[60:63], v[16:19]
    ds_read_b32 v234, v232
    v_and_b32_dpp v12, v36, v8 row_newbcast:9 row_mask:0xf bank_mask:0xf
    v_and_b32_dpp v13, v36, v9 row_newbcast:9 row_mask:0xf bank_mask:0xf
    v_and_b32_dpp v14, v36, v10 row_newbcast:9 row_mask:0xf bank_mask:0xf
    v_and_b32_dpp v15, v36, v11 row_newbcast:9 row_mask:0xf bank_mask:0xf
    s_waitcnt vmcnt(4)
    s_or_b32 s48, s47, 106496
    buffer_load_dwordx4 v[84:87], v1, s[40:43], s48 offen nt
    v_mfma_f32_16x16x32_bf16 v[16:19], v[12:15], v[64:67], v[16:19]
    v_add_u32 v233, 4, v233
    ds_write_b32 v38, v233 offset:128
    v_and_b32_dpp v12, v36, v8 row_newbcast:13 row_mask:0xf bank_mask:0xf
    v_and_b32_dpp v13, v36, v9 row_newbcast:13 row_mask:0xf bank_mask:0xf
    v_and_b32_dpp v14, v36, v10 row_newbcast:13 row_mask:0xf bank_mask:0xf
    v_and_b32_dpp v15, v36, v11 row_newbcast:13 row_mask:0xf bank_mask:0xf
    s_waitcnt vmcnt(4)
    s_or_b32 s48, s47, 67584
    buffer_load_dwordx4 v[88:91], v1, s[40:43], s48 offen nt
    v_mfma_f32_16x16x32_bf16 v[16:19], v[12:15], v[68:71], v[16:19]
    s_waitcnt lgkmcnt(0)
    v_readfirstlane_b32 s59, v234
    s_cmp_lg_u32 s59, 5
    s_cbranch_scc1 L_v5_x
    v_and_b32_dpp v12, v36, v8 row_newbcast:2 row_mask:0xf bank_mask:0xf
    v_and_b32_dpp v13, v36, v9 row_newbcast:2 row_mask:0xf bank_mask:0xf
    v_and_b32_dpp v14, v36, v10 row_newbcast:2 row_mask:0xf bank_mask:0xf
    v_and_b32_dpp v15, v36, v11 row_newbcast:2 row_mask:0xf bank_mask:0xf
    s_waitcnt vmcnt(4)
    s_or_b32 s48, s47, 75776
    buffer_load_dwordx4 v[92:95], v1, s[40:43], s48 offen nt
    v_mfma_f32_16x16x32_bf16 v[16:19], v[12:15], v[72:75], v[16:19]
L_v5_9:
    v_and_b32_dpp v12, v36, v8 row_newbcast:6 row_mask:0xf bank_mask:0xf
    v_and_b32_dpp v13, v36, v9 row_newbcast:6 row_mask:0xf bank_mask:0xf
    v_and_b32_dpp v14, v36, v10 row_newbcast:6 row_mask:0xf bank_mask:0xf
    v_and_b32_dpp v15, v36, v11 row_newbcast:6 row_mask:0xf bank_mask:0xf
    s_waitcnt vmcnt(4)
    s_or_b32 s48, s47, 100352
    buffer_load_dwordx4 v[96:99], v1, s[40:43], s48 offen nt
    v_mfma_f32_16x16x32_bf16 v[16:19], v[12:15], v[76:79], v[16:19]
    v_and_b32_dpp v12, v36, v8 row_newbcast:10 row_mask:0xf bank_mask:0xf
    v_and_b32_dpp v13, v36, v9 row_newbcast:10 row_mask:0xf bank_mask:0xf
    v_and_b32_dpp v14, v36, v10 row_newbcast:10 row_mask:0xf bank_mask:0xf
    v_and_b32_dpp v15, v36, v11 row_newbcast:10 row_mask:0xf bank_mask:0xf
    s_waitcnt vmcnt(4)
    s_or_b32 s48, s47, 108544
    buffer_load_dwordx4 v[100:103], v1, s[40:43], s48 offen nt
    v_mfma_f32_16x16x32_bf16 v[16:19], v[12:15], v[80:83], v[16:19]
    v_add_u32 v233, 4, v233
    ds_write_b32 v38, v233 offset:128
    s_cmp_lg_u32 s49, 1
    s_cbranch_scc1 L_nl1
    s_mov_b32 s42, 0
    ds_write_b32 v38, v38 offset:32
    s_mov_b32 s75, 0x200000
L_sp2:
    ds_read_b32 v3, v38 offset:16
    s_waitcnt lgkmcnt(0)
    v_readfirstlane_b32 s59, v3
    s_cmp_lg_u32 s59, -1
    s_cbranch_scc1 L_spd3
    s_sub_u32 s75, s75, 1
    s_cbranch_scc1 L_spd3
    s_sleep 1
    s_branch L_sp2
L_spd3:
    ds_read_b32 v20, v22
L_nl1:
    v_and_b32_dpp v12, v36, v8 row_newbcast:14 row_mask:0xf bank_mask:0xf
    v_and_b32_dpp v13, v36, v9 row_newbcast:14 row_mask:0xf bank_mask:0xf
    v_and_b32_dpp v14, v36, v10 row_newbcast:14 row_mask:0xf bank_mask:0xf
    v_and_b32_dpp v15, v36, v11 row_newbcast:14 row_mask:0xf bank_mask:0xf
    s_waitcnt vmcnt(4)
    s_or_b32 s47, s47, 0xffe1fbff
    s_add_u32 s47, s47, 1
    s_and_b32 s47, s47, 0x1e0400
    buffer_load_dwordx4 v[40:43], v1, s[40:43], s47 offen nt
    v_mfma_f32_16x16x32_bf16 v[16:19], v[12:15], v[84:87], v[16:19]
    v_and_b32_dpp v12, v36, v8 row_newbcast:3 row_mask:0xf bank_mask:0xf
    v_and_b32_dpp v13, v36, v9 row_newbcast:3 row_mask:0xf bank_mask:0xf
    v_and_b32_dpp v14, v36, v10 row_newbcast:3 row_mask:0xf bank_mask:0xf
    v_and_b32_dpp v15, v36, v11 row_newbcast:3 row_mask:0xf bank_mask:0xf
    s_waitcnt vmcnt(4)
    s_or_b32 s48, s47, 8192
    buffer_load_dwordx4 v[44:47], v1, s[40:43], s48 offen nt
    v_mfma_f32_16x16x32_bf16 v[16:19], v[12:15], v[88:91], v[16:19]
    v_and_b32_dpp v12, v36, v8 row_newbcast:7 row_mask:0xf bank_mask:0xf
    v_and_b32_dpp v13, v36, v9 row_newbcast:7 row_mask:0xf bank_mask:0xf
    v_and_b32_dpp v14, v36, v10 row_newbcast:7 row_mask:0xf bank_mask:0xf
    v_and_b32_dpp v15, v36, v11 row_newbcast:7 row_mask:0xf bank_mask:0xf
    s_waitcnt vmcnt(4)
    s_or_b32 s48, s47, 32768
    buffer_load_dwordx4 v[48:51], v1, s[40:43], s48 offen nt
    v_mfma_f32_16x16x32_bf16 v[16:19], v[12:15], v[92:95], v[16:19]
    ds_read_b32 v234, v232
    v_and_b32_dpp v12, v36, v8 row_newbcast:11 row_mask:0xf bank_mask:0xf
    v_and_b32_dpp v13, v36, v9 row_newbcast:11 row_mask:0xf bank_mask:0xf
    v_and_b32_dpp v14, v36, v10 row_newbcast:11 row_mask:0xf bank_mask:0xf
    v_and_b32_dpp v15, v36, v11 row_newbcast:11 row_mask:0xf bank_mask:0xf
    s_waitcnt vmcnt(4)
    s_or_b32 s48, s47, 40960
    buffer_load_dwordx4 v[52:55], v1, s[40:43], s48 offen nt
    v_mfma_f32_16x16x32_bf16 v[16:19], v[12:15], v[96:99], v[16:19]
    v_add_u32 v233, 4, v233
    ds_write_b32 v38, v233 offset:128
    v_and_b32_dpp v12, v36, v8 row_newbcast:15 row_mask:0xf bank_mask:0xf
    v_and_b32_dpp v13, v36, v9 row_newbcast:15 row_mask:0xf bank_mask:0xf
    v_and_b32_dpp v14, v36, v10 row_newbcast:15 row_mask:0xf bank_mask:0xf
    v_and_b32_dpp v15, v36, v11 row_newbcast:15 row_mask:0xf bank_mask:0xf
    s_waitcnt vmcnt(4)
    s_or_b32 s48, s47, 2048
    buffer_load_dwordx4 v[56:59], v1, s[40:43], s48 offen nt
    v_mfma_f32_16x16x32_bf16 v[16:19], v[12:15], v[100:103], v[16:19]
    s_sub_u32 s49, s49, 1
    s_cmp_eq_u32 s49, 0
    s_cbranch_scc0 L_v5_n
    s_mov_b32 exec_lo, 0xffffffff
    s_mov_b32 exec_hi, 0
    s_waitcnt lgkmcnt(0)
    v_readfirstlane_b32 s58, v20
    s_nop 0
    v_pk_mul_f32 v[16:17], v[16:17], v[2:3] op_sel:[0,1] op_sel_hi:[1,1]
    v_pk_mul_f32 v[18:19], v[18:19], v[2:3] op_sel:[0,1] op_sel_hi:[1,1]
    ds_write_b128 v39, v[16:19] offset:33024
    s_mov_b32 exec_lo, 1
    ds_add_rtn_u32 v20, v22, v23 offset:12
    s_mov_b32 exec_lo, -1
    s_waitcnt lgkmcnt(0)
    v_readfirstlane_b32 s59, v20
    s_cmp_lg_u32 s59, 2
    s_cbranch_scc1 L_S_done
    ds_read_b128 v[104:107], v21 offset:33024
    ds_read_b128 v[108:111], v21 offset:33536
    ds_read_b128 v[112:115], v21 offset:34048
    ds_read_b128 v[116:119], v21 offset:34560
    s_cmp_eq_u32 s58, 0
    s_waitcnt lgkmcnt(2)
    v_pk_add_f32 v[104:105], v[104:105], v[108:109]
    v_pk_add_f32 v[106:107], v[106:107], v[110:111]
    s_waitcnt lgkmcnt(0)
    v_pk_add_f32 v[112:113], v[112:113], v[116:117]
    v_pk_add_f32 v[114:115], v[114:115], v[118:119]
    v_pk_add_f32 v[104:105], v[104:105], v[112:113]
    v_pk_add_f32 v[106:107], v[106:107], v[114:115]
    s_cbranch_scc1 L_S_far
    buffer_store_dwordx4 v[104:107], v21, s[60:63], s5 offen
    s_branch L_S_pub
L_v5_n:
    s_waitcnt lgkmcnt(0)
    v_readfirstlane_b32 s59, v234
    s_cmp_eq_u32 s59, 5
    s_cbranch_scc1 L_v5_0
    s_or_b32 s48, s47, 10240
    buffer_load_dwordx4 v[60:63], v1, s[40:43], s48 offen nt
    s_branch L_v6_0
L_v5_x:
    s_or_b32 s48, s47, 75776
    buffer_load_dwordx4 v[92:95], v1, s[40:43], s48 offen nt
    s_branch L_v6_8
.p2align 3
L_v6_0:
    s_waitcnt lgkmcnt(0)
    v_fma_f32 v36, v37, s57, -v35
    ds_read_b32 v37, v2 offset:256
    v_add_u32 v2, 256, v2
    v_exp_f32 v36, v36
    s_nop 0
    v_cvt_pk_bf16_f32 v36, v36, v36
    s_nop 1
    v_and_b32_dpp v12, v36, v8 row_newbcast:0 row_mask:0xf bank_mask:0xf
    v_and_b32_dpp v13, v36, v9 row_newbcast:0 row_mask:0xf bank_mask:0xf
    v_and_b32_dpp v14, v36, v10 row_newbcast:0 row_mask:0xf bank_mask:0xf
    v_and_b32_dpp v15, v36, v11 row_newbcast:0 row_mask:0xf bank_mask:0xf
    s_waitcnt vmcnt(5)
    s_or_b32 s48, s47, 34816
    buffer_load_dwordx4 v[64:67], v1, s[40:43], s48 offen nt
    v_mfma_f32_16x16x32_bf16 v[16:19], v[12:15], v[40:43], v[16:19]
    v_and_b32_dpp v12, v36, v8 row_newbcast:4 row_mask:0xf bank_mask:0xf
    v_and_b32_dpp v13, v36, v9 row_newbcast:4 row_mask:0xf bank_mask:0xf
    v_and_b32_dpp v14, v36, v10 row_newbcast:4 row_mask:0xf bank_mask:0xf
    v_and_b32_dpp v15, v36, v11 row_newbcast:4 row_mask:0xf bank_mask:0xf
    s_waitcnt vmcnt(5)
    s_or_b32 s48, s47, 43008
    buffer_load_dwordx4 v[68:71], v1, s[40:43], s48 offen nt
    v_mfma_f32_16x16x32_bf16 v[16:19], v[12:15], v[44:47], v[16:19]
    v_and_b32_dpp v12, v36, v8 row_newbcast:8 row_mask:0xf bank_mask:0xf
    v_and_b32_dpp v13, v36, v9 row_newbcast:8 row_mask:0xf bank_mask:0xf
    v_and_b32_dpp v14, v36, v10 row_newbcast:8 row_mask:0xf bank_mask:0xf
    v_and_b32_dpp v15, v36, v11 row_newbcast:8 row_mask:0xf bank_mask:0xf
    s_waitcnt vmcnt(5)
    s_or_b32 s48, s47, 65536
    buffer_load_dwordx4 v[72:75], v1, s[40:43], s48 offen nt
    v_mfma_f32_16x16x32_bf16 v[16:19], v[12:15], v[48:51], v[16:19]
    v_add_u32 v233, 4, v233
    ds_write_b32 v38, v233 offset:128
    v_and_b32_dpp v12, v36, v8 row_newbcast:12 row_mask:0xf bank_mask:0xf
    v_and_b32_dpp v13, v36, v9 row_newbcast:12 row_mask:0xf bank_mask:0xf
    v_and_b32_dpp v14, v36, v10 row_newbcast:12 row_mask:0xf bank_mask:0xf
    v_and_b32_dpp v15, v36, v11 row_newbcast:12 row_mask:0xf bank_mask:0xf
    s_waitcnt vmcnt(5)
    s_or_b32 s48, s47, 73728
    buffer_load_dwordx4 v[76:79], v1, s[40:43], s48 offen nt
    v_mfma_f32_16x16x32_bf16 v[16:19], v[12:15], v[52:55], v[16:19]
    v_and_b32_dpp v12, v36, v8 row_newbcast:1 row_mask:0xf bank_mask:0xf
    v_and_b32_dpp v13, v36, v9 row_newbcast:1 row_mask:0xf bank_mask:0xf
    v_and_b32_dpp v14, v36, v10 row_newbcast:1 row_mask:0xf bank_mask:0xf
    v_and_b32_dpp v15, v36, v11 row_newbcast:1 row_mask:0xf bank_mask:0xf
    s_waitcnt vmcnt(5)
    s_or_b32 s48, s47, 98304
    buffer_load_dwordx4 v[80:83], v1, s[40:43], s48 offen nt
    v_mfma_f32_16x16x32_bf16 v[16:19], v[12:15], v[56:59], v[16:19]
    v_and_b32_dpp v12, v36, v8 row_newbcast:5 row_mask:0xf bank_mask:0xf
    v_and_b32_dpp v13, v36, v9 row_newbcast:5 row_mask:0xf bank_mask:0xf
    v_and_b32_dpp v14, v36, v10 row_newbcast:5 row_mask:0xf bank_mask:0xf
    v_and_b32_dpp v15, v36, v11 row_newbcast:5 row_mask:0xf bank_mask:0xf
    s_waitcnt vmcnt(5)
    s_or_b32 s48, s47, 106496
    buffer_load_dwordx4 v[84:87], v1, s[40:43], s48 offen nt
    v_mfma_f32_16x16x32_bf16 v[16:19], v[12:15], v[60:63], v[16:19]
    ds_read_b32 v234, v232
    v_and_b32_dpp v12, v36, v8 row_newbcast:9 row_mask:0xf bank_mask:0xf
    v_and_b32_dpp v13, v36, v9 row_newbcast:9 row_mask:0xf bank_mask:0xf
    v_and_b32_dpp v14, v36, v10 row_newbcast:9 row_mask:0xf bank_mask:0xf
    v_and_b32_dpp v15, v36, v11 row_newbcast:9 row_mask:0xf bank_mask:0xf
    s_waitcnt vmcnt(5)
    s_or_b32 s48, s47, 67584
    buffer_load_dwordx4 v[88:91], v1, s[40:43], s48 offen nt
    v_mfma_f32_16x16x32_bf16 v[16:19], v[12:15], v[64:67], v[16:19]
    v_add_u32 v233, 4, v233
    ds_write_b32 v38, v233 offset:128
    v_and_b32_dpp v12, v36, v8 row_newbcast:13 row_mask:0xf bank_mask:0xf
    v_and_b32_dpp v13, v36, v9 row_newbcast:13 row_mask:0xf bank_mask:0xf
    v_and_b32_dpp v14, v36, v10 row_newbcast:13 row_mask:0xf bank_mask:0xf
    v_and_b32_dpp v15, v36, v11 row_newbcast:13 row_mask:0xf bank_mask:0xf
    s_waitcnt vmcnt(5)
    s_or_b32 s48, s47, 75776
    buffer_load_dwordx4 v[92:95], v1, s[40:43], s48 offen nt
    v_mfma_f32_16x16x32_bf16 v[16:19], v[12:15], v[68:71], v[16:19]
    s_waitcnt lgkmcnt(0)
    v_readfirstlane_b32 s59, v234
    s_cmp_lg_u32 s59, 6
    s_cbranch_scc1 L_v6_x
L_v6_8:
    v_and_b32_dpp v12, v36, v8 row_newbcast:2 row_mask:0xf bank_mask:0xf
    v_and_b32_dpp v13, v36, v9 row_newbcast:2 row_mask:0xf bank_mask:0xf
    v_and_b32_dpp v14, v36, v10 row_newbcast:2 row_mask:0xf bank_mask:0xf
    v_and_b32_dpp v15, v36, v11 row_newbcast:2 row_mask:0xf bank_mask:0xf
    s_waitcnt vmcnt(5)
    s_or_b32 s48, s47, 100352
    buffer_load_dwordx4 v[96:99], v1, s[40:43], s48 offen nt
    v_mfma_f32_16x16x32_bf16 v[16:19], v[12:15], v[72:75], v[16:19]
    v_and_b32_dpp v12, v36, v8 row_newbcast:6 row_mask:0xf bank_mask:0xf
    v_and_b32_dpp v13, v36, v9 row_newbcast:6 row_mask:0xf bank_mask:0xf
    v_and_b32_dpp v14, v36, v10 row_newbcast:6 row_mask:0xf bank_mask:0xf
    v_and_b32_dpp v15, v36, v11 row_newbcast:6 row_mask:0xf bank_mask:0xf
    s_waitcnt vmcnt(5)
    s_or_b32 s48, s47, 108544
    buffer_load_dwordx4 v[100:103], v1, s[40:43], s48 offen nt
    v_mfma_f32_16x16x32_bf16 v[16:19], v[12:15], v[76:79], v[16:19]
    s_cmp_lg_u32 s49, 1
    s_cbranch_scc1 L_nl4
    s_mov_b32 s42, 0
    ds_write_b32 v38, v38 offset:32
    s_mov_b32 s75, 0x200000
L_sp5:
    ds_read_b32 v3, v38 offset:16
    s_waitcnt lgkmcnt(0)
    v_readfirstlane_b32 s59, v3
    s_cmp_lg_u32 s59, -1
    s_cbranch_scc1 L_spd6
    s_sub_u32 s75, s75, 1
    s_cbranch_scc1 L_spd6
    s_sleep 1
    s_branch L_sp5
L_spd6:
    ds_read_b32 v20, v22
L_nl4:
    v_and_b32_dpp v12, v36, v8 row_newbcast:10 row_mask:0xf bank_mask:0xf
    v_and_b32_dpp v13, v36, v9 row_newbcast:10 row_mask:0xf bank_mask:0xf
    v_and_b32_dpp v14, v36, v10 row_newbcast:10 row_mask:0xf bank_mask:0xf
    v_and_b32_dpp v15, v36, v11 row_newbcast:10 row_mask:0xf bank_mask:0xf
    s_waitcnt vmcnt(5)
    s_or_b32 s47, s47, 0xffe1fbff
    s_add_u32 s47, s47, 1
    s_and_b32 s47, s47, 0x1e0400
    buffer_load_dwordx4 v[40:43], v1, s[40:43], s47 offen nt
    v_mfma_f32_16x16x32_bf16 v[16:19], v[12:15], v[80:83], v[16:19]
    v_add_u32 v233, 4, v233
    ds_write_b32 v38, v233 offset:128
    v_and_b32_dpp v12, v36, v8 row_newbcast:14 row_mask:0xf bank_mask:0xf
    v_and_b32_dpp v13, v36, v9 row_newbcast:14 row_mask:0xf bank_mask:0xf
    v_and_b32_dpp v14, v36, v10 row_newbcast:14 row_mask:0xf bank_mask:0xf
    v_and_b32_dpp v15, v36, v11 row_newbcast:14 row_mask:0xf bank_mask:0xf
    s_waitcnt vmcnt(5)
    s_or_b32 s48, s47, 8192
    buffer_load_dwordx4 v[44:47], v1, s[40:43], s48 offen nt
    v_mfma_f32_16x16x32_bf16 v[16:19], v[12:15], v[84:87], v[16:19]
    v_and_b32_dpp v12, v36, v8 row_newbcast:3 row_mask:0xf bank_mask:0xf
    v_and_b32_dpp v13, v36, v9 row_newbcast:3 row_mask:0xf bank_mask:0xf
    v_and_b32_dpp v14, v36, v10 row_newbcast:3 row_mask:0xf bank_mask:0xf
    v_and_b32_dpp v15, v36, v11 row_newbcast:3 row_mask:0xf bank_mask:0xf
    s_waitcnt vmcnt(5)
    s_or_b32 s48, s47, 32768
    buffer_load_dwordx4 v[48:51], v1, s[40:43], s48 offen nt
    v_mfma_f32_16x16x32_bf16 v[16:19], v[12:15], v[88:91], v[16:19]
    v_and_b32_dpp v12, v36, v8 row_newbcast:7 row_mask:0xf bank_mask:0xf
    v_and_b32_dpp v13, v36, v9 row_newbcast:7 row_mask:0xf bank_mask:0xf
    v_and_b32_dpp v14, v36, v10 row_newbcast:7 row_mask:0xf bank_mask:0xf
    v_and_b32_dpp v15, v36, v11 row_newbcast:7 row_mask:0xf bank_mask:0xf
    s_waitcnt vmcnt(5)
    s_or_b32 s48, s47, 40960
    buffer_load_dwordx4 v[52:55], v1, s[40:43], s48 offen nt
    v_mfma_f32_16x16x32_bf16 v[16:19], v[12:15], v[92:95], v[16:19]
    ds_read_b32 v234, v232
    v_and_b32_dpp v12, v36, v8 row_newbcast:11 row_mask:0xf bank_mask:0xf
    v_and_b32_dpp v13, v36, v9 row_newbcast:11 row_mask:0xf bank_mask:0xf
    v_and_b32_dpp v14, v36, v10 row_newbcast:11 row_mask:0xf bank_mask:0xf
    v_and_b32_dpp v15, v36, v11 row_newbcast:11 row_mask:0xf bank_mask:0xf
    s_waitcnt vmcnt(5)
    s_or_b32 s48, s47, 2048
    buffer_load_dwordx4 v[56:59], v1, s[40:43], s48 offen nt
    v_mfma_f32_16x16x32_bf16 v[16:19], v[12:15], v[96:99], v[16:19]
    v_add_u32 v233, 4, v233
    ds_write_b32 v38, v233 offset:128
    v_and_b32_dpp v12, v36, v8 row_newbcast:15 row_mask:0xf bank_mask:0xf
    v_and_b32_dpp v13, v36, v9 row_newbcast:15 row_mask:0xf bank_mask:0xf
    v_and_b32_dpp v14, v36, v10 row_newbcast:15 row_mask:0xf bank_mask:0xf
    v_and_b32_dpp v15, v36, v11 row_newbcast:15 row_mask:0xf bank_mask:0xf
    s_waitcnt vmcnt(5)
    s_or_b32 s48, s47, 10240
    buffer_load_dwordx4 v[60:63], v1, s[40:43], s48 offen nt
    v_mfma_f32_16x16x32_bf16 v[16:19], v[12:15], v[100:103], v[16:19]
    s_sub_u32 s49, s49, 1
    s_cmp_eq_u32 s49, 0
    s_cbranch_scc0 L_v6_n
    s_mov_b32 exec_lo, 0xffffffff
    s_mov_b32 exec_hi, 0
    s_waitcnt lgkmcnt(0)
    v_readfirstlane_b32 s58, v20
    s_nop 0
    v_pk_mul_f32 v[16:17], v[16:17], v[2:3] op_sel:[0,1] op_sel_hi:[1,1]
    v_pk_mul_f32 v[18:19], v[18:19], v[2:3] op_sel:[0,1] op_sel_hi:[1,1]
    ds_write_b128 v39, v[16:19] offset:33024
    s_mov_b32 exec_lo, 1
    ds_add_rtn_u32 v20, v22, v23 offset:12
    s_mov_b32 exec_lo, -1
    s_waitcnt lgkmcnt(0)
    v_readfirstlane_b32 s59, v20
    s_cmp_lg_u32 s59, 2
    s_cbranch_scc1 L_S_done
    ds_read_b128 v[104:107], v21 offset:33024
    ds_read_b128 v[108:111], v21 offset:33536
    ds_read_b128 v[112:115], v21 offset:34048
    ds_read_b128 v[116:119], v21 offset:34560
    s_cmp_eq_u32 s58, 0
    s_waitcnt lgkmcnt(2)
    v_pk_add_f32 v[104:105], v[104:105], v[108:109]
    v_pk_add_f32 v[106:107], v[106:107], v[110:111]
    s_waitcnt lgkmcnt(0)
    v_pk_add_f32 v[112:113], v[112:113], v[116:117]
    v_pk_add_f32 v[114:115], v[114:115], v[118:119]
    v_pk_add_f32 v[104:105], v[104:105], v[112:113]
    v_pk_add_f32 v[106:107], v[106:107], v[114:115]
    s_cbranch_scc1 L_S_far
    buffer_store_dwordx4 v[104:107], v21, s[60:63], s5 offen
    s_branch L_S_pub
L_v6_n:
    s_waitcnt lgkmcnt(0)
    v_readfirstlane_b32 s59, v234
    s_cmp_eq_u32 s59, 6
    s_cbranch_scc1 L_v6_0
    s_waitcnt lgkmcnt(0)
    v_fma_f32 v36, v37, s57, -v35
    ds_read_b32 v37, v2 offset:256
    v_add_u32 v2, 256, v2
    v_exp_f32 v36, v36
    s_nop 0
    v_cvt_pk_bf16_f32 v36, v36, v36
    s_nop 1
    v_and_b32_dpp v12, v36, v8 row_newbcast:0 row_mask:0xf bank_mask:0xf
    v_and_b32_dpp v13, v36, v9 row_newbcast:0 row_mask:0xf bank_mask:0xf
    v_and_b32_dpp v14, v36, v10 row_newbcast:0 row_mask:0xf bank_mask:0xf
    v_and_b32_dpp v15, v36, v11 row_newbcast:0 row_mask:0xf bank_mask:0xf
    s_waitcnt vmcnt(5)
    s_nop 0
    v_mfma_f32_16x16x32_bf16 v[16:19], v[12:15], v[40:43], v[16:19]
    s_branch L_v5_1
L_v6_x:
    v_and_b32_dpp v12, v36, v8 row_newbcast:2 row_mask:0xf bank_mask:0xf
    v_and_b32_dpp v13, v36, v9 row_newbcast:2 row_mask:0xf bank_mask:0xf
    v_and_b32_dpp v14, v36, v10 row_newbcast:2 row_mask:0xf bank_mask:0xf
    v_and_b32_dpp v15, v36, v11 row_newbcast:2 row_mask:0xf bank_mask:0xf
    s_waitcnt vmcnt(5)
    s_nop 0
    v_mfma_f32_16x16x32_bf16 v[16:19], v[12:15], v[72:75], v[16:19]
    s_branch L_v5_9
L_S_far:
    buffer_store_dwordx4 v[104:107], v21, s[60:63], s5 offen sc1
L_S_pub:
    s_mov_b32 exec_lo, 1
    ds_add_u32 v22, v23 offset:12
    s_waitcnt lgkmcnt(0)
L_S_done:
    s_endpgm
L_H123:
    v_mov_b32 v28, -1
    v_lshlrev_b32 v29, 2, v0
    v_cmp_le_u32 vcc, 32, v0
    s_nop 1
    v_cndmask_b32 v28, v28, 0, vcc
    v_cmp_le_u32 vcc, 36, v0
    s_nop 1
    v_cndmask_b32 v28, v28, 5, vcc
    ds_write_b32 v29, v28 offset:35072
    s_waitcnt lgkmcnt(0)
L_Hc:
    s_load_dword s74, s[36:37], 532484
    s_load_dwordx4 s[28:31], s[0:1], 48
    s_load_dwordx4 s[32:35], s[0:1], 64
    v_and_b32 v32, 1, v0
    v_lshlrev_b32 v32, 4, v32
    v_mov_b32 v33, 0xffff
    v_lshlrev_b32 v32, v32, v33
    v_bfe_u32 v33, v0, 1, 3
    v_cmp_eq_u32 vcc, 0, v33
    s_nop 1
    v_cndmask_b32 v4, 0, v32, vcc
    v_cmp_eq_u32 vcc, 1, v33
    s_nop 1
    v_cndmask_b32 v5, 0, v32, vcc
    v_cmp_eq_u32 vcc, 2, v33
    s_nop 1
    v_cndmask_b32 v6, 0, v32, vcc
    v_cmp_eq_u32 vcc, 3, v33
    s_nop 1
    v_cndmask_b32 v7, 0, v32, vcc
    s_mov_b32 s57, 0x3fb8aa3b
    s_mov_b32 s73, 0x3727c5ac
    s_mov_b32 s72, 0x3b000000
    v_mov_b32 v20, 0
    v_mov_b32 v21, 0
    v_mov_b32 v22, 0
    v_mov_b32 v23, 0
    v_lshlrev_b32 v28, 4, v2
    v_lshl_add_u32 v28, v3, 5, v28
    s_waitcnt lgkmcnt(0)
    s_mov_b32 s60, s36
    s_mov_b32 s61, s37
    s_mov_b32 s62, 638976
    s_mov_b32 s63, 0x20000
    s_add_u32 s74, s74, 0x9e3779b0
    s_mov_b32 s93, s74
    s_getreg_b32 s5, hwreg(HW_REG_XCC_ID, 0, 3)
    s_andn2_b32 s74, s74, 15
    s_or_b32 s74, s74, s5
    s_cmp_lg_u32 s7, 0
    s_cbranch_scc1 L_qdone
    s_lshl_b32 s5, s4, 10
    s_add_u32 s5, s5, 270336
    s_lshl_b32 s6, s8, 13
    s_add_u32 s6, s6, 270336
    s_add_u32 s9, s6, 4096
    v_lshlrev_b32 v48, 10, v2
    v_lshl_add_u32 v48, v3, 6, v48
    v_and_b32 v49, 1, v2
    v_lshlrev_b32 v49, 5, v49
    v_lshl_add_u32 v49, v3, 6, v49
    v_lshrrev_b32 v50, 5, v0
    v_lshl_add_u32 v49, v50, 4, v49
    v_mov_b32 v53, s74
    v_mov_b32 v55, s74
    s_waitcnt vmcnt(16)
    v_lshlrev_b32 v32, 16, v24
    v_and_b32 v33, 0xffff0000, v24
    v_lshlrev_b32 v34, 16, v25
    v_and_b32 v35, 0xffff0000, v25
    v_lshlrev_b32 v36, 16, v26
    v_and_b32 v37, 0xffff0000, v26
    v_lshlrev_b32 v38, 16, v27
    v_and_b32 v39, 0xffff0000, v27
    v_lshlrev_b32 v29, 16, v29
    v_pk_add_f32 v[40:41], v[32:33], v[34:35]
    v_pk_add_f32 v[42:43], v[36:37], v[38:39]
    v_pk_add_f32 v[40:41], v[40:41], v[42:43]
    v_add_f32 v30, v40, v41
    s_nop 1
    v_add_f32_dpp v30, v30, v30 quad_perm:[1,0,3,2] row_mask:0xf bank_mask:0xf
    s_nop 1
    v_add_f32_dpp v30, v30, v30 quad_perm:[2,3,0,1] row_mask:0xf bank_mask:0xf
    s_nop 1
    v_add_f32_dpp v30, v30, v30 row_half_mirror row_mask:0xf bank_mask:0xf
    s_nop 1
    v_add_f32_dpp v30, v30, v30 row_mirror row_mask:0xf bank_mask:0xf
    v_mov_b32 v40, v30
    s_nop 1
    v_permlane16_swap_b32 v30, v40
    v_add_f32 v30, v30, v40
    v_mov_b32 v40, v30
    s_nop 1
    v_permlane32_swap_b32 v30, v40
    v_add_f32 v30, v30, v40
    v_mul_f32 v30, s72, v30
    v_sub_f32 v32, v32, v30
    v_sub_f32 v33, v33, v30
    v_sub_f32 v34, v34, v30
    v_sub_f32 v35, v35, v30
    v_sub_f32 v36, v36, v30
    v_sub_f32 v37, v37, v30
    v_sub_f32 v38, v38, v30
    v_sub_f32 v39, v39, v30
    v_mul_f32 v40, v32, v32
    v_mul_f32 v41, v33, v33
    v_fmac_f32 v40, v34, v34
    v_fmac_f32 v41, v35, v35
    v_fmac_f32 v40, v36, v36
    v_fmac_f32 v41, v37, v37
    v_fmac_f32 v40, v38, v38
    v_fmac_f32 v41, v39, v39
    v_add_f32 v40, v40, v41
    s_nop 1
    v_add_f32_dpp v40, v40, v40 quad_perm:[1,0,3,2] row_mask:0xf bank_mask:0xf
    s_nop 1
    v_add_f32_dpp v40, v40, v40 quad_perm:[2,3,0,1] row_mask:0xf bank_mask:0xf
    s_nop 1
    v_add_f32_dpp v40, v40, v40 row_half_mirror row_mask:0xf bank_mask:0xf
    s_nop 1
    v_add_f32_dpp v40, v40, v40 row_mirror row_mask:0xf bank_mask:0xf
    v_mov_b32 v41, v40
    s_nop 1
    v_permlane16_swap_b32 v40, v41
    v_add_f32 v40, v40, v41
    v_mov_b32 v41, v40
    s_nop 1
    v_permlane32_swap_b32 v40, v41
    v_add_f32 v40, v40, v41
    v_mul_f32 v40, s72, v40
    v_cvt_pk_bf16_f32 v40, v40, v40
    v_and_b32 v40, 0xffff0000, v40
    v_add_f32 v40, s73, v40
    v_cvt_pk_bf16_f32 v40, v40, v40
    v_and_b32 v40, 0xffff0000, v40
    v_sqrt_f32 v40, v40
    v_cvt_pk_bf16_f32 v30, v30, v30
    v_and_b32 v30, 0xffff0000, v30
    v_cvt_pk_bf16_f32 v40, v40, v40
    v_and_b32 v40, 0xffff0000, v40
    v_rcp_f32 v41, v40
    v_sub_f32 v29, v29, v30
    v_cvt_pk_bf16_f32 v29, v29, v29
    v_and_b32 v29, 0xffff0000, v29
    v_mul_f32 v31, v29, v41
    v_fma_f32 v29, -v31, v40, v29
    v_fma_f32 v29, v29, v41, v31
    v_cvt_pk_bf16_f32 v29, v29, v29
    s_nop 1
    v_and_b32_dpp v12, v29, v4 row_newbcast:0 row_mask:0xf bank_mask:0xf
    v_and_b32_dpp v13, v29, v5 row_newbcast:0 row_mask:0xf bank_mask:0xf
    v_and_b32_dpp v14, v29, v6 row_newbcast:0 row_mask:0xf bank_mask:0xf
    v_and_b32_dpp v15, v29, v7 row_newbcast:0 row_mask:0xf bank_mask:0xf
    v_and_b32_dpp v16, v29, v4 row_newbcast:1 row_mask:0xf bank_mask:0xf
    v_and_b32_dpp v17, v29, v5 row_newbcast:1 row_mask:0xf bank_mask:0xf
    v_and_b32_dpp v18, v29, v6 row_newbcast:1 row_mask:0xf bank_mask:0xf
    v_and_b32_dpp v19, v29, v7 row_newbcast:1 row_mask:0xf bank_mask:0xf
    s_waitcnt vmcnt(15)
    v_mfma_f32_16x16x32_bf16 v[20:23], v[12:15], v[64:67], v[20:23]
    v_and_b32_dpp v12, v29, v4 row_newbcast:2 row_mask:0xf bank_mask:0xf
    v_and_b32_dpp v13, v29, v5 row_newbcast:2 row_mask:0xf bank_mask:0xf
    v_and_b32_dpp v14, v29, v6 row_newbcast:2 row_mask:0xf bank_mask:0xf
    v_and_b32_dpp v15, v29, v7 row_newbcast:2 row_mask:0xf bank_mask:0xf
    s_waitcnt vmcnt(14)
    v_mfma_f32_16x16x32_bf16 v[20:23], v[16:19], v[68:71], v[20:23]
    v_and_b32_dpp v16, v29, v4 row_newbcast:3 row_mask:0xf bank_mask:0xf
    v_and_b32_dpp v17, v29, v5 row_newbcast:3 row_mask:0xf bank_mask:0xf
    v_and_b32_dpp v18, v29, v6 row_newbcast:3 row_mask:0xf bank_mask:0xf
    v_and_b32_dpp v19, v29, v7 row_newbcast:3 row_mask:0xf bank_mask:0xf
    s_waitcnt vmcnt(13)
    v_mfma_f32_16x16x32_bf16 v[20:23], v[12:15], v[72:75], v[20:23]
    v_and_b32_dpp v12, v29, v4 row_newbcast:4 row_mask:0xf bank_mask:0xf
    v_and_b32_dpp v13, v29, v5 row_newbcast:4 row_mask:0xf bank_mask:0xf
    v_and_b32_dpp v14, v29, v6 row_newbcast:4 row_mask:0xf bank_mask:0xf
    v_and_b32_dpp v15, v29, v7 row_newbcast:4 row_mask:0xf bank_mask:0xf
    s_waitcnt vmcnt(12)
    v_mfma_f32_16x16x32_bf16 v[20:23], v[16:19], v[76:79], v[20:23]
    v_and_b32_dpp v16, v29, v4 row_newbcast:5 row_mask:0xf bank_mask:0xf
    v_and_b32_dpp v17, v29, v5 row_newbcast:5 row_mask:0xf bank_mask:0xf
    v_and_b32_dpp v18, v29, v6 row_newbcast:5 row_mask:0xf bank_mask:0xf
    v_and_b32_dpp v19, v29, v7 row_newbcast:5 row_mask:0xf bank_mask:0xf
    s_waitcnt vmcnt(11)
    v_mfma_f32_16x16x32_bf16 v[20:23], v[12:15], v[80:83], v[20:23]
    v_and_b32_dpp v12, v29, v4 row_newbcast:6 row_mask:0xf bank_mask:0xf
    v_and_b32_dpp v13, v29, v5 row_newbcast:6 row_mask:0xf bank_mask:0xf
    v_and_b32_dpp v14, v29, v6 row_newbcast:6 row_mask:0xf bank_mask:0xf
    v_and_b32_dpp v15, v29, v7 row_newbcast:6 row_mask:0xf bank_mask:0xf
    s_waitcnt vmcnt(10)
    v_mfma_f32_16x16x32_bf16 v[20:23], v[16:19], v[84:87], v[20:23]
    v_and_b32_dpp v16, v29, v4 row_newbcast:7 row_mask:0xf bank_mask:0xf
    v_and_b32_dpp v17, v29, v5 row_newbcast:7 row_mask:0xf bank_mask:0xf
    v_and_b32_dpp v18, v29, v6 row_newbcast:7 row_mask:0xf bank_mask:0xf
    v_and_b32_dpp v19, v29, v7 row_newbcast:7 row_mask:0xf bank_mask:0xf
    s_waitcnt vmcnt(9)
    v_mfma_f32_16x16x32_bf16 v[20:23], v[12:15], v[88:91], v[20:23]
    v_and_b32_dpp v12, v29, v4 row_newbcast:8 row_mask:0xf bank_mask:0xf
    v_and_b32_dpp v13, v29, v5 row_newbcast:8 row_mask:0xf bank_mask:0xf
    v_and_b32_dpp v14, v29, v6 row_newbcast:8 row_mask:0xf bank_mask:0xf
    v_and_b32_dpp v15, v29, v7 row_newbcast:8 row_mask:0xf bank_mask:0xf
    s_waitcnt vmcnt(8)
    v_mfma_f32_16x16x32_bf16 v[20:23], v[16:19], v[92:95], v[20:23]
    v_and_b32_dpp v16, v29, v4 row_newbcast:9 row_mask:0xf bank_mask:0xf
    v_and_b32_dpp v17, v29, v5 row_newbcast:9 row_mask:0xf bank_mask:0xf
    v_and_b32_dpp v18, v29, v6 row_newbcast:9 row_mask:0xf bank_mask:0xf
    v_and_b32_dpp v19, v29, v7 row_newbcast:9 row_mask:0xf bank_mask:0xf
    s_waitcnt vmcnt(7)
    v_mfma_f32_16x16x32_bf16 v[20:23], v[12:15], v[96:99], v[20:23]
    v_and_b32_dpp v12, v29, v4 row_newbcast:10 row_mask:0xf bank_mask:0xf
    v_and_b32_dpp v13, v29, v5 row_newbcast:10 row_mask:0xf bank_mask:0xf
    v_and_b32_dpp v14, v29, v6 row_newbcast:10 row_mask:0xf bank_mask:0xf
    v_and_b32_dpp v15, v29, v7 row_newbcast:10 row_mask:0xf bank_mask:0xf
    s_waitcnt vmcnt(6)
    v_mfma_f32_16x16x32_bf16 v[20:23], v[16:19], v[100:103], v[20:23]
    v_and_b32_dpp v16, v29, v4 row_newbcast:11 row_mask:0xf bank_mask:0xf
    v_and_b32_dpp v17, v29, v5 row_newbcast:11 row_mask:0xf bank_mask:0xf
    v_and_b32_dpp v18, v29, v6 row_newbcast:11 row_mask:0xf bank_mask:0xf
    v_and_b32_dpp v19, v29, v7 row_newbcast:11 row_mask:0xf bank_mask:0xf
    s_waitcnt vmcnt(5)
    v_mfma_f32_16x16x32_bf16 v[20:23], v[12:15], v[104:107], v[20:23]
    v_and_b32_dpp v12, v29, v4 row_newbcast:12 row_mask:0xf bank_mask:0xf
    v_and_b32_dpp v13, v29, v5 row_newbcast:12 row_mask:0xf bank_mask:0xf
    v_and_b32_dpp v14, v29, v6 row_newbcast:12 row_mask:0xf bank_mask:0xf
    v_and_b32_dpp v15, v29, v7 row_newbcast:12 row_mask:0xf bank_mask:0xf
    s_waitcnt vmcnt(4)
    v_mfma_f32_16x16x32_bf16 v[20:23], v[16:19], v[108:111], v[20:23]
    v_and_b32_dpp v16, v29, v4 row_newbcast:13 row_mask:0xf bank_mask:0xf
    v_and_b32_dpp v17, v29, v5 row_newbcast:13 row_mask:0xf bank_mask:0xf
    v_and_b32_dpp v18, v29, v6 row_newbcast:13 row_mask:0xf bank_mask:0xf
    v_and_b32_dpp v19, v29, v7 row_newbcast:13 row_mask:0xf bank_mask:0xf
    s_waitcnt vmcnt(3)
    v_mfma_f32_16x16x32_bf16 v[20:23], v[12:15], v[112:115], v[20:23]
    v_and_b32_dpp v12, v29, v4 row_newbcast:14 row_mask:0xf bank_mask:0xf
    v_and_b32_dpp v13, v29, v5 row_newbcast:14 row_mask:0xf bank_mask:0xf
    v_and_b32_dpp v14, v29, v6 row_newbcast:14 row_mask:0xf bank_mask:0xf
    v_and_b32_dpp v15, v29, v7 row_newbcast:14 row_mask:0xf bank_mask:0xf
    s_waitcnt vmcnt(2)
    v_mfma_f32_16x16x32_bf16 v[20:23], v[16:19], v[116:119], v[20:23]
    v_and_b32_dpp v16, v29, v4 row_newbcast:15 row_mask:0xf bank_mask:0xf
    v_and_b32_dpp v17, v29, v5 row_newbcast:15 row_mask:0xf bank_mask:0xf
    v_and_b32_dpp v18, v29, v6 row_newbcast:15 row_mask:0xf bank_mask:0xf
    v_and_b32_dpp v19, v29, v7 row_newbcast:15 row_mask:0xf bank_mask:0xf
    s_waitcnt vmcnt(1)
    v_mfma_f32_16x16x32_bf16 v[20:23], v[12:15], v[120:123], v[20:23]
    s_waitcnt vmcnt(0)
    v_mfma_f32_16x16x32_bf16 v[20:23], v[16:19], v[124:127], v[20:23]
    s_nop 7
    v_permlane32_swap_b32 v20, v22
    v_permlane32_swap_b32 v21, v23
    v_mov_b32 v52, v20
    v_mov_b32 v54, v21
    buffer_store_dwordx4 v[52:55], v49, s[60:63], s5 offen
    s_waitcnt vmcnt(0)
    s_mov_b64 s[40:41], -1
    s_mov_b64 s[42:43], -1
    s_mov_b64 s[44:45], -1
    s_mov_b64 s[46:47], -1
    s_mov_b64 s[48:49], -1
    s_mov_b64 s[50:51], -1
    s_mov_b64 s[52:53], -1
    s_mov_b64 s[54:55], -1
    s_mov_b32 s75, 15
L_pt7:
    s_mov_b64 exec, s[40:41]
    buffer_load_dwordx4 v[64:67], v48, s[60:63], s6 offen offset:0 nt
    s_mov_b64 exec, s[42:43]
    buffer_load_dwordx4 v[68:71], v48, s[60:63], s6 offen offset:16 nt
    s_mov_b64 exec, s[44:45]
    buffer_load_dwordx4 v[72:75], v48, s[60:63], s6 offen offset:32 nt
    s_mov_b64 exec, s[46:47]
    buffer_load_dwordx4 v[76:79], v48, s[60:63], s6 offen offset:48 nt
    s_mov_b64 exec, s[48:49]
    buffer_load_dwordx4 v[80:83], v48, s[60:63], s9 offen offset:0 nt
    s_mov_b64 exec, s[50:51]
    buffer_load_dwordx4 v[84:87], v48, s[60:63], s9 offen offset:16 nt
    s_mov_b64 exec, s[52:53]
    buffer_load_dwordx4 v[88:91], v48, s[60:63], s9 offen offset:32 nt
    s_mov_b64 exec, s[54:55]
    buffer_load_dwordx4 v[92:95], v48, s[60:63], s9 offen offset:48 nt
    s_mov_b64 exec, -1
    s_mov_b64 s[58:59], 0
    s_waitcnt vmcnt(0)
    v_xor_b32 v46, s74, v65
    v_xor_b32 v47, s74, v67
    v_or_b32 v46, v46, v47
    v_cmp_lt_u32 s[40:41], 0, v46
    v_xor_b32 v46, s74, v69
    v_xor_b32 v47, s74, v71
    v_or_b32 v46, v46, v47
    v_cmp_lt_u32 s[42:43], 0, v46
    v_xor_b32 v46, s74, v73
    v_xor_b32 v47, s74, v75
    v_or_b32 v46, v46, v47
    v_cmp_lt_u32 s[44:45], 0, v46
    v_xor_b32 v46, s74, v77
    v_xor_b32 v47, s74, v79
    v_or_b32 v46, v46, v47
    v_cmp_lt_u32 s[46:47], 0, v46
    v_xor_b32 v46, s74, v81
    v_xor_b32 v47, s74, v83
    v_or_b32 v46, v46, v47
    v_cmp_lt_u32 s[48:49], 0, v46
    v_xor_b32 v46, s74, v85
    v_xor_b32 v47, s74, v87
    v_or_b32 v46, v46, v47
    v_cmp_lt_u32 s[50:51], 0, v46
    v_xor_b32 v46, s74, v89
    v_xor_b32 v47, s74, v91
    v_or_b32 v46, v46, v47
    v_cmp_lt_u32 s[52:53], 0, v46
    v_xor_b32 v46, s74, v93
    v_xor_b32 v47, s74, v95
    v_or_b32 v46, v46, v47
    v_cmp_lt_u32 s[54:55], 0, v46
    s_or_b64 s[58:59], s[58:59], s[40:41]
    s_or_b64 s[58:59], s[58:59], s[42:43]
    s_or_b64 s[58:59], s[58:59], s[44:45]
    s_or_b64 s[58:59], s[58:59], s[46:47]
    s_or_b64 s[58:59], s[58:59], s[48:49]
    s_or_b64 s[58:59], s[58:59], s[50:51]
    s_or_b64 s[58:59], s[58:59], s[52:53]
    s_or_b64 s[58:59], s[58:59], s[54:55]
    s_cbranch_scc0 L_qgot
    s_sub_u32 s75, s75, 1
    s_cbranch_scc1 L_ptf8
    s_sleep 4
    s_branch L_pt7
L_ptf8:
    buffer_store_dwordx4 v[52:55], v49, s[60:63], s5 offen sc1
    s_mov_b64 s[40:41], -1
    s_mov_b64 s[42:43], -1
    s_mov_b64 s[44:45], -1
    s_mov_b64 s[46:47], -1
    s_mov_b64 s[48:49], -1
    s_mov_b64 s[50:51], -1
    s_mov_b64 s[52:53], -1
    s_mov_b64 s[54:55], -1
    s_mov_b32 s75, 262143
L_pt9:
    s_mov_b64 exec, s[40:41]
    buffer_load_dwordx4 v[64:67], v48, s[60:63], s6 offen offset:0 sc1
    s_mov_b64 exec, s[42:43]
    buffer_load_dwordx4 v[68:71], v48, s[60:63], s6 offen offset:16 sc1
    s_mov_b64 exec, s[44:45]
    buffer_load_dwordx4 v[72:75], v48, s[60:63], s6 offen offset:32 sc1
    s_mov_b64 exec, s[46:47]
    buffer_load_dwordx4 v[76:79], v48, s[60:63], s6 offen offset:48 sc1
    s_mov_b64 exec, s[48:49]
    buffer_load_dwordx4 v[80:83], v48, s[60:63], s9 offen offset:0 sc1
    s_mov_b64 exec, s[50:51]
    buffer_load_dwordx4 v[84:87], v48, s[60:63], s9 offen offset:16 sc1
    s_mov_b64 exec, s[52:53]
    buffer_load_dwordx4 v[88:91], v48, s[60:63], s9 offen offset:32 sc1
    s_mov_b64 exec, s[54:55]
    buffer_load_dwordx4 v[92:95], v48, s[60:63], s9 offen offset:48 sc1
    s_mov_b64 exec, -1
    s_mov_b64 s[58:59], 0
    s_waitcnt vmcnt(0)
    v_xor_b32 v46, s74, v65
    v_xor_b32 v47, s74, v67
    v_or_b32 v46, v46, v47
    v_cmp_lt_u32 s[40:41], 15, v46
    v_xor_b32 v46, s74, v69
    v_xor_b32 v47, s74, v71
    v_or_b32 v46, v46, v47
    v_cmp_lt_u32 s[42:43], 15, v46
    v_xor_b32 v46, s74, v73
    v_xor_b32 v47, s74, v75
    v_or_b32 v46, v46, v47
    v_cmp_lt_u32 s[44:45], 15, v46
    v_xor_b32 v46, s74, v77
    v_xor_b32 v47, s74, v79
    v_or_b32 v46, v46, v47
    v_cmp_lt_u32 s[46:47], 15, v46
    v_xor_b32 v46, s74, v81
    v_xor_b32 v47, s74, v83
    v_or_b32 v46, v46, v47
    v_cmp_lt_u32 s[48:49], 15, v46
    v_xor_b32 v46, s74, v85
    v_xor_b32 v47, s74, v87
    v_or_b32 v46, v46, v47
    v_cmp_lt_u32 s[50:51], 15, v46
    v_xor_b32 v46, s74, v89
    v_xor_b32 v47, s74, v91
    v_or_b32 v46, v46, v47
    v_cmp_lt_u32 s[52:53], 15, v46
    v_xor_b32 v46, s74, v93
    v_xor_b32 v47, s74, v95
    v_or_b32 v46, v46, v47
    v_cmp_lt_u32 s[54:55], 15, v46
    s_or_b64 s[58:59], s[58:59], s[40:41]
    s_or_b64 s[58:59], s[58:59], s[42:43]
    s_or_b64 s[58:59], s[58:59], s[44:45]
    s_or_b64 s[58:59], s[58:59], s[46:47]
    s_or_b64 s[58:59], s[58:59], s[48:49]
    s_or_b64 s[58:59], s[58:59], s[50:51]
    s_or_b64 s[58:59], s[58:59], s[52:53]
    s_or_b64 s[58:59], s[58:59], s[54:55]
    s_cbranch_scc0 L_qgot
    s_sub_u32 s75, s75, 1
    s_cbranch_scc1 L_ptf10
    s_sleep 8
    s_branch L_pt9
L_ptf10:
L_qgot:
    v_add_f32 v32, v64, v80
    v_add_f32 v33, v66, v82
    v_add_f32 v34, v68, v84
    v_add_f32 v35, v70, v86
    v_add_f32 v36, v72, v88
    v_add_f32 v37, v74, v90
    v_add_f32 v38, v76, v92
    v_add_f32 v39, v78, v94
    v_mov_b32 v64, v32
    v_mov_b32 v65, v33
    v_mov_b32 v66, v34
    v_mov_b32 v67, v35
    v_mov_b32 v68, v36
    v_mov_b32 v69, v37
    v_mov_b32 v70, v38
    v_mov_b32 v71, v39
    v_permlane16_swap_b32 v32, v64
    v_permlane16_swap_b32 v33, v65
    v_permlane16_swap_b32 v34, v66
    v_permlane16_swap_b32 v35, v67
    v_permlane16_swap_b32 v36, v68
    v_permlane16_swap_b32 v37, v69
    v_permlane16_swap_b32 v38, v70
    v_permlane16_swap_b32 v39, v71
    v_pk_add_f32 v[32:33], v[32:33], v[64:65]
    v_pk_add_f32 v[34:35], v[34:35], v[66:67]
    v_pk_add_f32 v[36:37], v[36:37], v[68:69]
    v_pk_add_f32 v[38:39], v[38:39], v[70:71]
    v_mov_b32 v64, v32
    v_mov_b32 v65, v33
    v_mov_b32 v66, v34
    v_mov_b32 v67, v35
    v_mov_b32 v68, v36
    v_mov_b32 v69, v37
    v_mov_b32 v70, v38
    v_mov_b32 v71, v39
    v_permlane32_swap_b32 v32, v64
    v_permlane32_swap_b32 v33, v65
    v_permlane32_swap_b32 v34, v66
    v_permlane32_swap_b32 v35, v67
    v_permlane32_swap_b32 v36, v68
    v_permlane32_swap_b32 v37, v69
    v_permlane32_swap_b32 v38, v70
    v_permlane32_swap_b32 v39, v71
    v_pk_add_f32 v[32:33], v[32:33], v[64:65]
    v_pk_add_f32 v[34:35], v[34:35], v[66:67]
    v_pk_add_f32 v[36:37], v[36:37], v[68:69]
    v_pk_add_f32 v[38:39], v[38:39], v[70:71]
    v_cvt_pk_bf16_f32 v64, v32, v33
    v_cvt_pk_bf16_f32 v65, v34, v35
    v_cvt_pk_bf16_f32 v66, v36, v37
    v_cvt_pk_bf16_f32 v67, v38, v39
    s_mov_b32 exec_lo, 0xffff
    s_mov_b32 exec_hi, 0
    ds_write_b128 v1, v[64:67] offset:32768
    s_mov_b64 exec, -1
L_qdone:
    s_waitcnt lgkmcnt(0)
    s_barrier
    s_mov_b32 s68, s34
    s_mov_b32 s69, s35
    s_mov_b32 s70, 256
    s_mov_b32 s71, 0x20000
    s_cmp_lg_u32 s7, 2
    s_cbranch_scc1 L_noinit
    s_cmpk_lt_u32 s2, 248
    s_cbranch_scc1 L_noinit
    v_mov_b32 v32, -1
    v_mov_b32 v33, -1
    v_mov_b32 v34, -1
    v_mov_b32 v35, -1
    s_sub_u32 s6, s2, 248
    s_mul_i32 s5, s6, 32768
    s_add_u32 s5, s5, 8192
    buffer_store_dwordx4 v[32:35], v1, s[60:63], s5 offen offset:0 sc1
    buffer_store_dwordx4 v[32:35], v1, s[60:63], s5 offen offset:1024 sc1
    buffer_store_dwordx4 v[32:35], v1, s[60:63], s5 offen offset:2048 sc1
    buffer_store_dwordx4 v[32:35], v1, s[60:63], s5 offen offset:3072 sc1
    s_add_u32 s5, s5, 4096
    buffer_store_dwordx4 v[32:35], v1, s[60:63], s5 offen offset:0 sc1
    buffer_store_dwordx4 v[32:35], v1, s[60:63], s5 offen offset:1024 sc1
    buffer_store_dwordx4 v[32:35], v1, s[60:63], s5 offen offset:2048 sc1
    buffer_store_dwordx4 v[32:35], v1, s[60:63], s5 offen offset:3072 sc1
    s_add_u32 s5, s5, 4096
    buffer_store_dwordx4 v[32:35], v1, s[60:63], s5 offen offset:0 sc1
    buffer_store_dwordx4 v[32:35], v1, s[60:63], s5 offen offset:1024 sc1
    buffer_store_dwordx4 v[32:35], v1, s[60:63], s5 offen offset:2048 sc1
    buffer_store_dwordx4 v[32:35], v1, s[60:63], s5 offen offset:3072 sc1
    s_add_u32 s5, s5, 4096
    buffer_store_dwordx4 v[32:35], v1, s[60:63], s5 offen offset:0 sc1
    buffer_store_dwordx4 v[32:35], v1, s[60:63], s5 offen offset:1024 sc1
    buffer_store_dwordx4 v[32:35], v1, s[60:63], s5 offen offset:2048 sc1
    buffer_store_dwordx4 v[32:35], v1, s[60:63], s5 offen offset:3072 sc1
    s_add_u32 s5, s5, 4096
    buffer_store_dwordx4 v[32:35], v1, s[60:63], s5 offen offset:0 sc1
    buffer_store_dwordx4 v[32:35], v1, s[60:63], s5 offen offset:1024 sc1
    buffer_store_dwordx4 v[32:35], v1, s[60:63], s5 offen offset:2048 sc1
    buffer_store_dwordx4 v[32:35], v1, s[60:63], s5 offen offset:3072 sc1
    s_add_u32 s5, s5, 4096
    buffer_store_dwordx4 v[32:35], v1, s[60:63], s5 offen offset:0 sc1
    buffer_store_dwordx4 v[32:35], v1, s[60:63], s5 offen offset:1024 sc1
    buffer_store_dwordx4 v[32:35], v1, s[60:63], s5 offen offset:2048 sc1
    buffer_store_dwordx4 v[32:35], v1, s[60:63], s5 offen offset:3072 sc1
    s_add_u32 s5, s5, 4096
    buffer_store_dwordx4 v[32:35], v1, s[60:63], s5 offen offset:0 sc1
    buffer_store_dwordx4 v[32:35], v1, s[60:63], s5 offen offset:1024 sc1
    buffer_store_dwordx4 v[32:35], v1, s[60:63], s5 offen offset:2048 sc1
    buffer_store_dwordx4 v[32:35], v1, s[60:63], s5 offen offset:3072 sc1
    s_add_u32 s5, s5, 4096
    buffer_store_dwordx4 v[32:35], v1, s[60:63], s5 offen offset:0 sc1
    buffer_store_dwordx4 v[32:35], v1, s[60:63], s5 offen offset:1024 sc1
    buffer_store_dwordx4 v[32:35], v1, s[60:63], s5 offen offset:2048 sc1
    buffer_store_dwordx4 v[32:35], v1, s[60:63], s5 offen offset:3072 sc1
    s_add_u32 s5, s5, 4096
    s_lshl_b32 s6, s6, 2
    v_mov_b32 v36, 1
    v_mov_b32 v37, s6
    s_mov_b32 exec_lo, 0x1
    s_mov_b32 exec_hi, 0
    s_waitcnt vmcnt(0)
    buffer_store_dword v36, v37, s[68:71], 0 offen sc1
    s_mov_b64 exec, -1
L_noinit:
    s_lshl_b32 s5, s7, 2
    s_add_u32 s5, s5, 35072
    v_mov_b32 v30, s5
    s_cmp_lg_u32 s7, 1
    s_cbranch_scc1 L_sweep0
    v_and_b32 v32, 3, v0
    v_lshlrev_b32 v32, 2, v32
    v_and_b32 v33, 31, v0
    v_lshlrev_b32 v33, 3, v33
    s_lshr_b32 s6, s4, 5
    s_lshl_b32 s6, s6, 8
    v_mov_b32 v44, s6
    v_mov_b32 v41, 0x800
    v_cmp_le_u32 vcc, 32, v0
    s_nop 1
    v_cndmask_b32 v33, v33, v41, vcc
    s_and_b32 s50, s4, 31
    s_lshl_b32 s51, s50, 12
    s_add_u32 s51, s51, 2048
    s_mov_b32 s52, 0
    s_cmp_lt_u32 s50, 2
    s_cselect_b32 s52, 9, s52
    s_cmp_gt_u32 s50, 30
    s_cselect_b32 s52, 9, s52
    s_lshl_b32 s53, s50, 11
    s_add_u32 s53, s53, 540672
    v_and_b32 v45, 7, v0
    v_lshlrev_b32 v45, 8, v45
    v_mov_b32 v48, 0
    s_mov_b32 s54, 5
    v_mov_b32 v43, s74
    s_add_u32 s6, s6, 4096
    s_and_b32 s5, s4, 31
    s_lshl_b32 s5, s5, 3
    v_mov_b32 v34, s5
    v_mov_b32 v37, s74
    s_mov_b32 s75, 0x40000
    s_movk_i32 s14, 4000
    s_cmpk_lt_u32 s2, 128
    s_cselect_b32 s14, 3920, s14
L_ctl:
    ds_read_b32 v40, v32 offset:35200
    s_waitcnt lgkmcnt(0)
    v_add_u32_dpp v36, v40, v40 quad_perm:[1,0,3,2] row_mask:0xf bank_mask:0xf
    s_nop 1
    v_add_u32_dpp v36, v36, v36 quad_perm:[2,3,0,1] row_mask:0xf bank_mask:0xf
    s_mov_b32 exec_lo, 0x1
    s_mov_b32 exec_hi, 0
    buffer_store_dwordx2 v[36:37], v34, s[60:63], s6 offen
    s_mov_b64 exec, -1
    buffer_load_dwordx2 v[38:39], v33, s[60:63], s6 offen nt
    s_cmp_eq_u32 s52, 1
    s_cbranch_scc0 L_m1
    buffer_load_dwordx2 v[46:47], v45, s[60:63], s53 offen sc1
L_m1:
    v_readfirstlane_b32 s9, v36
    s_waitcnt vmcnt(0)
    v_cmp_eq_u32 vcc, s74, v39
    v_readlane_b32 s55, v38, 32
    s_bitcmp1_b32 vcc_hi, 0
    s_cselect_b32 s55, s55, 0
    v_cndmask_b32 v38, v36, v38, vcc
    v_cmp_gt_u32 s[12:13], s14, v38
    s_nop 0
    v_add_u32_dpp v38, v38, v38 quad_perm:[1,0,3,2] row_mask:0xf bank_mask:0xf
    s_nop 1
    v_add_u32_dpp v38, v38, v38 quad_perm:[2,3,0,1] row_mask:0xf bank_mask:0xf
    s_nop 1
    v_add_u32_dpp v38, v38, v38 row_half_mirror row_mask:0xf bank_mask:0xf
    s_nop 1
    v_add_u32_dpp v38, v38, v38 row_mirror row_mask:0xf bank_mask:0xf
    s_cmp_eq_u32 s12, 0
    s_cbranch_scc1 L_ctl_done
    v_readlane_b32 s10, v38, 0
    v_readlane_b32 s11, v38, 16
    s_add_u32 s10, s10, s11
    s_cmp_eq_u32 s52, 1
    s_cbranch_scc0 L_m2
    v_xor_b32 v47, s74, v47
    v_mov_b32 v42, s10
    v_cmp_gt_u32 vcc, 16, v47
    v_cmp_eq_u32 s[58:59], 0, v48
    s_and_b64 s[58:59], s[58:59], vcc
    s_nop 0
    v_cndmask_b32 v48, v48, v42, s[58:59]
    v_cndmask_b32 v46, 0, v46, vcc
    s_sub_u32 s54, s54, 1
    s_cselect_b64 s[58:59], -1, vcc
    s_cmp_eq_u64 s[58:59], -1
    s_cbranch_scc0 L_m3
    v_cmp_eq_u32 vcc, 0, v48
    s_nop 1
    v_cndmask_b32 v48, v48, v42, vcc
    v_sub_u32 v48, v48, v46
    s_add_u32 s58, s51, 1500
    v_subrev_u32 v48, s58, v48
    v_max_i32 v42, 0, v48
    s_nop 1
    v_max_i32_dpp v42, v42, v42 quad_perm:[1,0,3,2] row_mask:0xf bank_mask:0xf
    s_nop 1
    v_max_i32_dpp v42, v42, v42 quad_perm:[2,3,0,1] row_mask:0xf bank_mask:0xf
    s_nop 1
    v_max_i32_dpp v42, v42, v42 row_half_mirror row_mask:0xf bank_mask:0xf
    s_mov_b32 exec_lo, 0x1
    s_mov_b32 exec_hi, 0
    buffer_store_dwordx2 v[42:43], v41, s[60:63], s6 offen
    s_mov_b64 exec, -1
    s_mov_b32 s52, 2
    s_branch L_m3
L_m2:
    s_cmp_eq_u32 s52, 0
    s_cbranch_scc0 L_m3
    s_cmp_ge_u32 s10, s51
    s_cbranch_scc0 L_m3
    s_sub_u32 s58, s10, s51
    v_mov_b32 v42, s58
    s_mov_b32 exec_lo, 0x1
    s_mov_b32 exec_hi, 0
    buffer_store_dwordx2 v[42:43], v44, s[60:63], s53 offen sc1
    s_mov_b64 exec, -1
    s_mov_b32 s52, 1
L_m3:
    s_mul_i32 s55, s55, 2
    s_lshr_b32 s55, s55, 2
    s_sub_i32 s10, s10, s55
    v_lshlrev_b32 v40, 2, v40
    v_sub_u32 v40, v40, v36
    v_mul_i32_i24 v40, 32, v40
    s_lshl_b32 s11, s9, 5
    s_sub_i32 s10, s11, s10
    s_sub_i32 s10, s10, 384
    v_add_u32 v40, s10, v40
    v_cmp_gt_i32 vcc, 0, v40
    v_mov_b32 v38, 5
    s_nop 0
    v_cndmask_b32 v38, v38, 6, vcc
    ds_write_b32 v32, v38 offset:35216
    s_sub_u32 s75, s75, 1
    s_cbranch_scc1 L_ctl_done
    s_cmpk_ge_u32 s9, 3728
    s_cbranch_scc1 L_ctl
    s_sleep 8
    s_branch L_ctl
L_ctl_done:
    v_mov_b32 v36, 0x1000
    s_mov_b32 exec_lo, 0x1
    s_mov_b32 exec_hi, 0
    buffer_store_dwordx2 v[36:37], v34, s[60:63], s6 offen
    s_mov_b64 exec, -1
    v_mov_b32 v35, 35160
    ds_write_b32 v35, v35
    s_branch L_xdone
L_sweep0:
    s_mov_b32 s9, s7
L_sweep:
    s_lshl_b32 s5, s9, 2
    s_add_u32 s5, s5, 35072
    v_mov_b32 v35, s5
    s_mov_b32 s75, 0x200000
L_sp11:
    ds_read_b32 v31, v35 offset:0
    s_waitcnt lgkmcnt(0)
    v_readfirstlane_b32 s58, v31
    s_cmp_lg_u32 s58, -1
    s_cbranch_scc1 L_spd12
    s_sub_u32 s75, s75, 1
    s_cbranch_scc1 L_spd12
    s_sleep 8
    s_branch L_sp11
L_spd12:
    s_lshl_b32 s5, s9, 13
    v_add_u32 v29, s5, v1
    ds_read_b128 v[64:67], v29 offset:0
    ds_read_b128 v[68:71], v29 offset:1024
    ds_read_b128 v[72:75], v29 offset:2048
    ds_read_b128 v[76:79], v29 offset:3072
    ds_read_b128 v[80:83], v29 offset:4096
    ds_read_b128 v[84:87], v29 offset:5120
    ds_read_b128 v[88:91], v29 offset:6144
    ds_read_b128 v[92:95], v29 offset:7168
    v_mov_b32 v32, 0
    v_mov_b32 v33, 0
    s_waitcnt lgkmcnt(7)
    v_fma_f32 v64, v64, s57, -v31
    v_fma_f32 v65, v65, s57, -v31
    v_fma_f32 v66, v66, s57, -v31
    v_fma_f32 v67, v67, s57, -v31
    v_exp_f32 v64, v64
    v_exp_f32 v65, v65
    v_exp_f32 v66, v66
    v_exp_f32 v67, v67
    v_add_f32 v32, v32, v64
    v_add_f32 v33, v33, v65
    v_add_f32 v32, v32, v66
    v_add_f32 v33, v33, v67
    s_waitcnt lgkmcnt(6)
    v_fma_f32 v68, v68, s57, -v31
    v_fma_f32 v69, v69, s57, -v31
    v_fma_f32 v70, v70, s57, -v31
    v_fma_f32 v71, v71, s57, -v31
    v_exp_f32 v68, v68
    v_exp_f32 v69, v69
    v_exp_f32 v70, v70
    v_exp_f32 v71, v71
    v_add_f32 v32, v32, v68
    v_add_f32 v33, v33, v69
    v_add_f32 v32, v32, v70
    v_add_f32 v33, v33, v71
    s_waitcnt lgkmcnt(5)
    v_fma_f32 v72, v72, s57, -v31
    v_fma_f32 v73, v73, s57, -v31
    v_fma_f32 v74, v74, s57, -v31
    v_fma_f32 v75, v75, s57, -v31
    v_exp_f32 v72, v72
    v_exp_f32 v73, v73
    v_exp_f32 v74, v74
    v_exp_f32 v75, v75
    v_add_f32 v32, v32, v72
    v_add_f32 v33, v33, v73
    v_add_f32 v32, v32, v74
    v_add_f32 v33, v33, v75
    s_waitcnt lgkmcnt(4)
    v_fma_f32 v76, v76, s57, -v31
    v_fma_f32 v77, v77, s57, -v31
    v_fma_f32 v78, v78, s57, -v31
    v_fma_f32 v79, v79, s57, -v31
    v_exp_f32 v76, v76
    v_exp_f32 v77, v77
    v_exp_f32 v78, v78
    v_exp_f32 v79, v79
    v_add_f32 v32, v32, v76
    v_add_f32 v33, v33, v77
    v_add_f32 v32, v32, v78
    v_add_f32 v33, v33, v79
    s_waitcnt lgkmcnt(3)
    v_fma_f32 v80, v80, s57, -v31
    v_fma_f32 v81, v81, s57, -v31
    v_fma_f32 v82, v82, s57, -v31
    v_fma_f32 v83, v83, s57, -v31
    v_exp_f32 v80, v80
    v_exp_f32 v81, v81
    v_exp_f32 v82, v82
    v_exp_f32 v83, v83
    v_add_f32 v32, v32, v80
    v_add_f32 v33, v33, v81
    v_add_f32 v32, v32, v82
    v_add_f32 v33, v33, v83
    s_waitcnt lgkmcnt(2)
    v_fma_f32 v84, v84, s57, -v31
    v_fma_f32 v85, v85, s57, -v31
    v_fma_f32 v86, v86, s57, -v31
    v_fma_f32 v87, v87, s57, -v31
    v_exp_f32 v84, v84
    v_exp_f32 v85, v85
    v_exp_f32 v86, v86
    v_exp_f32 v87, v87
    v_add_f32 v32, v32, v84
    v_add_f32 v33, v33, v85
    v_add_f32 v32, v32, v86
    v_add_f32 v33, v33, v87
    s_waitcnt lgkmcnt(1)
    v_fma_f32 v88, v88, s57, -v31
    v_fma_f32 v89, v89, s57, -v31
    v_fma_f32 v90, v90, s57, -v31
    v_fma_f32 v91, v91, s57, -v31
    v_exp_f32 v88, v88
    v_exp_f32 v89, v89
    v_exp_f32 v90, v90
    v_exp_f32 v91, v91
    v_add_f32 v32, v32, v88
    v_add_f32 v33, v33, v89
    v_add_f32 v32, v32, v90
    v_add_f32 v33, v33, v91
    s_waitcnt lgkmcnt(0)
    v_fma_f32 v92, v92, s57, -v31
    v_fma_f32 v93, v93, s57, -v31
    v_fma_f32 v94, v94, s57, -v31
    v_fma_f32 v95, v95, s57, -v31
    v_exp_f32 v92, v92
    v_exp_f32 v93, v93
    v_exp_f32 v94, v94
    v_exp_f32 v95, v95
    v_add_f32 v32, v32, v92
    v_add_f32 v33, v33, v93
    v_add_f32 v32, v32, v94
    v_add_f32 v33, v33, v95
    v_add_f32 v33, v32, v33
    s_nop 1
    v_add_f32_dpp v33, v33, v33 quad_perm:[1,0,3,2] row_mask:0xf bank_mask:0xf
    s_nop 1
    v_add_f32_dpp v33, v33, v33 quad_perm:[2,3,0,1] row_mask:0xf bank_mask:0xf
    s_nop 1
    v_add_f32_dpp v33, v33, v33 row_half_mirror row_mask:0xf bank_mask:0xf
    s_nop 1
    v_add_f32_dpp v33, v33, v33 row_mirror row_mask:0xf bank_mask:0xf
    v_mov_b32 v34, v33
    s_nop 1
    v_permlane16_swap_b32 v33, v34
    v_add_f32 v33, v33, v34
    v_mov_b32 v34, v33
    s_nop 1
    v_permlane32_swap_b32 v33, v34
    v_add_f32 v33, v33, v34
    ds_write_b32 v35, v33 offset:48
    s_cmp_eq_u32 s9, 3
    s_mov_b32 s9, 1
    s_cbranch_scc1 L_sweep
    s_cmp_lg_u32 s7, 0
    s_cbranch_scc1 L_xdone
    v_and_b32 v35, 3, v0
    v_lshl_add_u32 v35, v35, 2, v30
    s_mov_b32 s75, 0x200000
L_lw:
    ds_read_b32 v33, v35 offset:48
    s_waitcnt lgkmcnt(0)
    v_cmp_eq_u32 vcc, -1, v33
    s_cbranch_vccz L_lw_done
    s_sub_u32 s75, s75, 1
    s_cbranch_scc1 L_lw_done
    s_sleep 8
    s_branch L_lw
L_lw_done:
    ds_read_b32 v31, v35
    s_waitcnt lgkmcnt(0)
    v_max_f32_dpp v52, v31, v31 quad_perm:[1,0,3,2] row_mask:0xf bank_mask:0xf
    s_nop 1
    v_max_f32_dpp v52, v52, v52 quad_perm:[2,3,0,1] row_mask:0xf bank_mask:0xf
    v_sub_f32 v34, v31, v52
    v_exp_f32 v34, v34
    s_nop 0
    v_mul_f32 v54, v33, v34
    s_nop 1
    v_add_f32_dpp v54, v54, v54 quad_perm:[1,0,3,2] row_mask:0xf bank_mask:0xf
    s_nop 1
    v_add_f32_dpp v54, v54, v54 quad_perm:[2,3,0,1] row_mask:0xf bank_mask:0xf
    s_lshl_b32 s5, s4, 7
    s_add_u32 s5, s5, 606208
    s_lshr_b32 s6, s4, 5
    s_lshl_b32 s6, s6, 12
    s_add_u32 s6, s6, 606208
    v_mov_b32 v34, 0
    v_and_b32 v48, 31, v0
    v_lshlrev_b32 v48, 7, v48
    s_mov_b32 exec_lo, 0x1
    s_mov_b32 exec_hi, 0
    buffer_store_dwordx4 v[52:55], v34, s[60:63], s5 offen
    s_mov_b64 exec, -1
    s_mov_b32 s75, 0x200000
L_mw:
    ds_read_b32 v36, v30 offset:128
    s_waitcnt lgkmcnt(0)
    v_readfirstlane_b32 s58, v36
    s_cmpk_ge_u32 s58, 768
    s_cbranch_scc1 L_mw_done
    s_sub_u32 s75, s75, 1
    s_cbranch_scc1 L_mw_done
    s_sleep 32
    s_branch L_mw
L_mw_done:
    v_and_b32 v36, 7, v0
    v_lshlrev_b32 v36, 2, v36
    s_mov_b32 s75, 0x40000
L_fl:
    buffer_load_dword v37, v36, s[68:71], 0 offen sc1
    s_waitcnt vmcnt(0)
    v_cmp_ne_u32 vcc, 1, v37
    s_cbranch_vccz L_fl_done
    s_sub_u32 s75, s75, 1
    s_cbranch_scc1 L_fl_done
    s_sleep 64
    s_branch L_fl
L_fl_done:
    s_mov_b64 s[40:41], -1
    s_mov_b32 s75, 3
L_pt13:
    s_mov_b64 exec, s[40:41]
    buffer_load_dwordx4 v[64:67], v48, s[60:63], s6 offen nt
    s_mov_b64 exec, -1
    s_mov_b64 s[58:59], 0
    s_waitcnt vmcnt(0)
    v_xor_b32 v46, s74, v65
    v_xor_b32 v47, s74, v67
    v_or_b32 v46, v46, v47
    v_cmp_lt_u32 s[40:41], 0, v46
    s_or_b64 s[58:59], s[58:59], s[40:41]
    s_cbranch_scc0 L_p0got
    s_sub_u32 s75, s75, 1
    s_cbranch_scc1 L_ptf14
    s_sleep 32
    s_branch L_pt13
L_ptf14:
    s_mov_b32 exec_lo, 0x1
    s_mov_b32 exec_hi, 0
    buffer_store_dwordx4 v[52:55], v34, s[60:63], s5 offen sc1
    s_mov_b64 exec, -1
    s_mov_b64 s[40:41], -1
    s_mov_b32 s75, 262143
L_pt15:
    s_mov_b64 exec, s[40:41]
    buffer_load_dwordx4 v[64:67], v48, s[60:63], s6 offen sc1
    s_mov_b64 exec, -1
    s_mov_b64 s[58:59], 0
    s_waitcnt vmcnt(0)
    v_xor_b32 v46, s74, v65
    v_xor_b32 v47, s74, v67
    v_or_b32 v46, v46, v47
    v_cmp_lt_u32 s[40:41], 15, v46
    s_or_b64 s[58:59], s[58:59], s[40:41]
    s_cbranch_scc0 L_p0got
    s_sub_u32 s75, s75, 1
    s_cbranch_scc1 L_ptf16
    s_sleep 32
    s_branch L_pt15
L_ptf16:
L_p0got:
    v_cmp_ne_u32 vcc, 0, v46
    s_cmp_eq_u64 vcc, 0
    s_cselect_b32 s5, 1, 0
    v_mov_b32 v36, s5
    v_mov_b32 v37, 35152
    ds_write_b32 v37, v36
    v_max_f32_dpp v38, v64, v64 quad_perm:[1,0,3,2] row_mask:0xf bank_mask:0xf
    s_nop 1
    v_max_f32_dpp v38, v38, v38 quad_perm:[2,3,0,1] row_mask:0xf bank_mask:0xf
    s_nop 1
    v_max_f32_dpp v38, v38, v38 row_half_mirror row_mask:0xf bank_mask:0xf
    v_sub_f32 v36, v64, v38
    v_exp_f32 v36, v36
    s_nop 0
    v_mul_f32 v37, v66, v36
    s_nop 1
    v_add_f32_dpp v37, v37, v37 quad_perm:[1,0,3,2] row_mask:0xf bank_mask:0xf
    s_nop 1
    v_add_f32_dpp v37, v37, v37 quad_perm:[2,3,0,1] row_mask:0xf bank_mask:0xf
    s_nop 1
    v_add_f32_dpp v37, v37, v37 row_half_mirror row_mask:0xf bank_mask:0xf
    s_and_b32 s5, s8, 3
    s_lshl_b32 s5, s5, 3
    v_rcp_f32 v37, v37
    v_readlane_b32 s58, v38, s5
    v_readlane_b32 s59, v37, s5
    s_nop 0
    v_subrev_f32 v31, s58, v31
    v_exp_f32 v31, v31
    s_nop 0
    v_mul_f32 v31, s59, v31
    ds_write_b32 v35, v31 offset:16
L_xdone:
    s_cmpk_ge_u32 s2, 192
    s_cbranch_scc1 L_H_done
    s_and_b32 s9, s2, 7
    s_lshr_b32 s10, s2, 3
    s_cmpk_lt_u32 s2, 128
    s_cbranch_scc1 L_role
    s_cmp_eq_u32 s9, 7
    s_cbranch_scc1 L_H_done
L_role:
    v_bfe_u32 v32, v0, 3, 1
    v_mul_u32_u24 v32, 0x202, v32
    v_add_u32 v32, 0x100, v32
    v_or_b32 v33, 0x0c0c0000, v32
    v_lshlrev_b32 v32, 16, v32
    v_or_b32 v32, 0x0c0c, v32
    v_and_b32 v34, 1, v0
    v_cmp_eq_u32 vcc, 1, v34
    s_nop 1
    v_cndmask_b32 v32, v33, v32, vcc
    v_bfe_u32 v33, v0, 1, 2
    v_mov_b32 v34, 0x0c0c0c0c
    v_cmp_eq_u32 vcc, 0, v33
    s_nop 1
    v_cndmask_b32 v8, v34, v32, vcc
    v_cmp_eq_u32 vcc, 1, v33
    s_nop 1
    v_cndmask_b32 v9, v34, v32, vcc
    v_cmp_eq_u32 vcc, 2, v33
    s_nop 1
    v_cndmask_b32 v10, v34, v32, vcc
    v_cmp_eq_u32 vcc, 3, v33
    s_nop 1
    v_cndmask_b32 v11, v34, v32, vcc
    v_bfe_u32 v40, v0, 4, 1
    v_lshlrev_b32 v40, 6, v40
    v_lshrrev_b32 v41, 5, v0
    v_lshl_add_u32 v40, v41, 1, v40
    v_bfe_u32 v44, v0, 3, 1
    v_lshl_add_u32 v40, v44, 5, v40
    v_bfe_u32 v44, v0, 2, 1
    v_add_u32 v40, v40, v44
    v_and_b32 v29, 31, v0
    v_lshlrev_b32 v29, 4, v29
    v_lshl_add_u32 v42, v41, 3, v29
    v_mov_b32 v31, v41
    v_and_b32 v41, 3, v0
    v_lshrrev_b32 v43, 1, v2
    v_lshlrev_b32 v43, 7, v43
    v_lshl_add_u32 v43, v41, 5, v43
    v_and_b32 v44, 1, v2
    v_lshl_add_u32 v43, v44, 4, v43
    s_lshl_b32 s5, s7, 8
    v_add_u32 v43, s5, v43
    s_cmpk_ge_u32 s2, 128
    s_cbranch_scc1 L_ffn
    s_mov_b32 s44, s26
    s_mov_b32 s45, s27
    s_mov_b32 s46, 4194304
    s_mov_b32 s47, 0x20000
    v_lshlrev_b32 v44, 10, v40
    v_lshl_add_u32 v44, v41, 4, v44
    s_lshl_b32 s11, s9, 2
    s_add_u32 s11, s11, s7
    s_lshl_b32 s48, s11, 17
    s_lshl_b32 s5, s10, 6
    s_add_u32 s48, s48, s5
    s_lshl_b32 s12, s11, 12
    s_add_u32 s12, s12, 8192
    s_lshl_b32 s13, s9, 11
    s_lshl_b32 s5, s10, 7
    s_add_u32 s13, s13, s5
    s_add_u32 s13, s13, 139264
    v_lshl_add_u32 v29, v31, 11, v29
    s_lshl_b32 s5, s7, 2
    v_mov_b32 v30, s5
    v_cmp_eq_u32 vcc, 4, v0
    s_nop 1
    v_cndmask_b32 v30, v30, 48, vcc
    v_cmp_le_u32 vcc, 5, v0
    s_nop 1
    v_cndmask_b32 v30, v30, 56, vcc
    s_mov_b32 s75, 0x200000
L_gw17:
    ds_read_b32 v31, v30 offset:35104
    s_waitcnt lgkmcnt(0)
    v_cmp_eq_u32 vcc, -1, v31
    s_cbranch_vccz L_gwd18
    s_sub_u32 s75, s75, 1
    s_cbranch_scc1 L_gwd18
    s_sleep 1
    s_branch L_gw17
L_gwd18:
    buffer_load_dwordx4 v[64:67], v44, s[44:47], s48 offen
    s_addk_i32 s48, 0x1000
    buffer_load_dwordx4 v[68:71], v44, s[44:47], s48 offen
    s_addk_i32 s48, 0x1000
    buffer_load_dwordx4 v[72:75], v44, s[44:47], s48 offen
    s_addk_i32 s48, 0x1000
    buffer_load_dwordx4 v[76:79], v44, s[44:47], s48 offen
    s_addk_i32 s48, 0x1000
    buffer_load_dwordx4 v[80:83], v44, s[44:47], s48 offen
    s_addk_i32 s48, 0x1000
    buffer_load_dwordx4 v[84:87], v44, s[44:47], s48 offen
    s_addk_i32 s48, 0x1000
    buffer_load_dwordx4 v[88:91], v44, s[44:47], s48 offen
    s_addk_i32 s48, 0x1000
    buffer_load_dwordx4 v[92:95], v44, s[44:47], s48 offen
    s_addk_i32 s48, 0x1000
    s_movk_i32 s75, 0xff
    s_movk_i32 s95, 0x1000
    v_mov_b32 v30, 35164
    s_mov_b32 s58, 0x200000
L_dw19:
    ds_read_b32 v31, v30
    s_waitcnt lgkmcnt(0)
    v_cmp_ne_u32 vcc, 4, v31
    s_cbranch_vccz L_dwd20
    s_sub_u32 s58, s58, 1
    s_cbranch_scc1 L_dwd20
    s_sleep 1
    s_branch L_dw19
L_dwd20:
L_ps21:
    buffer_load_dwordx4 v[192:195], v29, s[60:63], s12 offen offset:0 sc1
    buffer_load_dwordx4 v[196:199], v29, s[60:63], s12 offen offset:512 sc1
    buffer_load_dwordx4 v[200:203], v29, s[60:63], s12 offen offset:1024 sc1
    buffer_load_dwordx4 v[204:207], v29, s[60:63], s12 offen offset:1536 sc1
    s_waitcnt vmcnt(0)
    v_pk_add_f32 v[32:33], v[192:193], v[196:197]
    v_pk_add_f32 v[34:35], v[194:195], v[198:199]
    v_pk_add_f32 v[36:37], v[200:201], v[204:205]
    v_pk_add_f32 v[38:39], v[202:203], v[206:207]
    v_pk_add_f32 v[32:33], v[32:33], v[36:37]
    v_pk_add_f32 v[34:35], v[34:35], v[38:39]
    s_nop 1
    v_permlane32_swap_b32 v32, v34
    v_permlane32_swap_b32 v33, v35
    v_pk_add_f32 v[32:33], v[32:33], v[34:35]
    v_cmp_u_f32 vcc, v32, v33
    s_cbranch_vccz L_psd22
    s_sub_u32 s75, s75, 1
    s_cbranch_scc0 L_ps21
    v_mov_b32 v46, 0
    v_max3_u32 v46, v46, v192, v193
    v_max3_u32 v46, v46, v194, v195
    v_max3_u32 v46, v46, v196, v197
    v_max3_u32 v46, v46, v198, v199
    v_max3_u32 v46, v46, v200, v201
    v_max3_u32 v46, v46, v202, v203
    v_max3_u32 v46, v46, v204, v205
    v_max3_u32 v46, v46, v206, v207
    v_cmp_eq_u32 vcc, -1, v46
    s_cbranch_vccz L_psd22
    s_movk_i32 s75, 0xff
    s_sub_u32 s95, s95, 1
    s_cbranch_scc0 L_ps21
L_psd22:
    v_cvt_pk_bf16_f32 v47, v32, v33
    s_nop 1
    v_mov_b32_dpp v45, v47 row_newbcast:0 row_mask:0xf bank_mask:0xf
    v_perm_b32 v12, v45, v45, v8
    v_perm_b32 v13, v45, v45, v9
    v_perm_b32 v14, v45, v45, v10
    v_perm_b32 v15, v45, v45, v11
    v_mov_b32_dpp v45, v47 row_newbcast:8 row_mask:0xf bank_mask:0xf
    v_perm_b32 v16, v45, v45, v8
    v_perm_b32 v17, v45, v45, v9
    v_perm_b32 v18, v45, v45, v10
    v_perm_b32 v19, v45, v45, v11
    v_mfma_f32_16x16x32_bf16 v[20:23], v[12:15], v[64:67], 0
    v_mov_b32_dpp v45, v47 row_newbcast:1 row_mask:0xf bank_mask:0xf
    v_perm_b32 v12, v45, v45, v8
    v_perm_b32 v13, v45, v45, v9
    v_perm_b32 v14, v45, v45, v10
    v_perm_b32 v15, v45, v45, v11
    v_mfma_f32_16x16x32_bf16 v[24:27], v[16:19], v[64:67], 0
    v_mov_b32_dpp v45, v47 row_newbcast:9 row_mask:0xf bank_mask:0xf
    v_perm_b32 v16, v45, v45, v8
    v_perm_b32 v17, v45, v45, v9
    v_perm_b32 v18, v45, v45, v10
    v_perm_b32 v19, v45, v45, v11
    v_mfma_f32_16x16x32_bf16 v[20:23], v[12:15], v[68:71], v[20:23]
    v_mov_b32_dpp v45, v47 row_newbcast:2 row_mask:0xf bank_mask:0xf
    v_perm_b32 v12, v45, v45, v8
    v_perm_b32 v13, v45, v45, v9
    v_perm_b32 v14, v45, v45, v10
    v_perm_b32 v15, v45, v45, v11
    v_mfma_f32_16x16x32_bf16 v[24:27], v[16:19], v[68:71], v[24:27]
    v_mov_b32_dpp v45, v47 row_newbcast:10 row_mask:0xf bank_mask:0xf
    v_perm_b32 v16, v45, v45, v8
    v_perm_b32 v17, v45, v45, v9
    v_perm_b32 v18, v45, v45, v10
    v_perm_b32 v19, v45, v45, v11
    v_mfma_f32_16x16x32_bf16 v[20:23], v[12:15], v[72:75], v[20:23]
    v_mov_b32_dpp v45, v47 row_newbcast:3 row_mask:0xf bank_mask:0xf
    v_perm_b32 v12, v45, v45, v8
    v_perm_b32 v13, v45, v45, v9
    v_perm_b32 v14, v45, v45, v10
    v_perm_b32 v15, v45, v45, v11
    v_mfma_f32_16x16x32_bf16 v[24:27], v[16:19], v[72:75], v[24:27]
    v_mov_b32_dpp v45, v47 row_newbcast:11 row_mask:0xf bank_mask:0xf
    v_perm_b32 v16, v45, v45, v8
    v_perm_b32 v17, v45, v45, v9
    v_perm_b32 v18, v45, v45, v10
    v_perm_b32 v19, v45, v45, v11
    v_mfma_f32_16x16x32_bf16 v[20:23], v[12:15], v[76:79], v[20:23]
    v_mov_b32_dpp v45, v47 row_newbcast:4 row_mask:0xf bank_mask:0xf
    v_perm_b32 v12, v45, v45, v8
    v_perm_b32 v13, v45, v45, v9
    v_perm_b32 v14, v45, v45, v10
    v_perm_b32 v15, v45, v45, v11
    v_mfma_f32_16x16x32_bf16 v[24:27], v[16:19], v[76:79], v[24:27]
    v_mov_b32_dpp v45, v47 row_newbcast:12 row_mask:0xf bank_mask:0xf
    v_perm_b32 v16, v45, v45, v8
    v_perm_b32 v17, v45, v45, v9
    v_perm_b32 v18, v45, v45, v10
    v_perm_b32 v19, v45, v45, v11
    v_mfma_f32_16x16x32_bf16 v[20:23], v[12:15], v[80:83], v[20:23]
    v_mov_b32_dpp v45, v47 row_newbcast:5 row_mask:0xf bank_mask:0xf
    v_perm_b32 v12, v45, v45, v8
    v_perm_b32 v13, v45, v45, v9
    v_perm_b32 v14, v45, v45, v10
    v_perm_b32 v15, v45, v45, v11
    v_mfma_f32_16x16x32_bf16 v[24:27], v[16:19], v[80:83], v[24:27]
    v_mov_b32_dpp v45, v47 row_newbcast:13 row_mask:0xf bank_mask:0xf
    v_perm_b32 v16, v45, v45, v8
    v_perm_b32 v17, v45, v45, v9
    v_perm_b32 v18, v45, v45, v10
    v_perm_b32 v19, v45, v45, v11
    v_mfma_f32_16x16x32_bf16 v[20:23], v[12:15], v[84:87], v[20:23]
    v_mov_b32_dpp v45, v47 row_newbcast:6 row_mask:0xf bank_mask:0xf
    v_perm_b32 v12, v45, v45, v8
    v_perm_b32 v13, v45, v45, v9
    v_perm_b32 v14, v45, v45, v10
    v_perm_b32 v15, v45, v45, v11
    v_mfma_f32_16x16x32_bf16 v[24:27], v[16:19], v[84:87], v[24:27]
    v_mov_b32_dpp v45, v47 row_newbcast:14 row_mask:0xf bank_mask:0xf
    v_perm_b32 v16, v45, v45, v8
    v_perm_b32 v17, v45, v45, v9
    v_perm_b32 v18, v45, v45, v10
    v_perm_b32 v19, v45, v45, v11
    v_mfma_f32_16x16x32_bf16 v[20:23], v[12:15], v[88:91], v[20:23]
    v_mov_b32_dpp v45, v47 row_newbcast:7 row_mask:0xf bank_mask:0xf
    v_perm_b32 v12, v45, v45, v8
    v_perm_b32 v13, v45, v45, v9
    v_perm_b32 v14, v45, v45, v10
    v_perm_b32 v15, v45, v45, v11
    v_mfma_f32_16x16x32_bf16 v[24:27], v[16:19], v[88:91], v[24:27]
    v_mov_b32_dpp v45, v47 row_newbcast:15 row_mask:0xf bank_mask:0xf
    v_perm_b32 v16, v45, v45, v8
    v_perm_b32 v17, v45, v45, v9
    v_perm_b32 v18, v45, v45, v10
    v_perm_b32 v19, v45, v45, v11
    v_mfma_f32_16x16x32_bf16 v[20:23], v[12:15], v[92:95], v[20:23]
    s_nop 0
    v_mfma_f32_16x16x32_bf16 v[24:27], v[16:19], v[92:95], v[24:27]
    s_nop 7
    v_add_f32_dpp v20, v24, v20 row_ror:8 row_mask:0xf bank_mask:0xf
    v_add_f32_dpp v21, v25, v21 row_ror:8 row_mask:0xf bank_mask:0xf
    v_add_f32_dpp v22, v26, v22 row_ror:8 row_mask:0xf bank_mask:0xf
    v_add_f32_dpp v23, v27, v23 row_ror:8 row_mask:0xf bank_mask:0xf
    s_mov_b32 exec_lo, 0x000f000f
    s_mov_b32 exec_hi, 0x00f000f0
    ds_write_b128 v43, v[20:23] offset:35328
    s_mov_b64 exec, -1
    s_waitcnt lgkmcnt(0)
    s_barrier
    s_cmp_lg_u32 s7, 0
    s_cbranch_scc1 L_H_done
    s_mov_b32 exec_lo, 0xff
    s_mov_b32 exec_hi, 0
    ds_read_b128 v[64:67], v1 offset:35328
    ds_read_b128 v[68:71], v1 offset:35456
    ds_read_b128 v[72:75], v1 offset:35584
    ds_read_b128 v[76:79], v1 offset:35712
    ds_read_b128 v[80:83], v1 offset:35840
    ds_read_b128 v[84:87], v1 offset:35968
    ds_read_b128 v[88:91], v1 offset:36096
    ds_read_b128 v[92:95], v1 offset:36224
    s_waitcnt lgkmcnt(6)
    v_pk_add_f32 v[64:65], v[64:65], v[68:69]
    v_pk_add_f32 v[66:67], v[66:67], v[70:71]
    s_waitcnt lgkmcnt(4)
    v_pk_add_f32 v[72:73], v[72:73], v[76:77]
    v_pk_add_f32 v[74:75], v[74:75], v[78:79]
    s_waitcnt lgkmcnt(2)
    v_pk_add_f32 v[80:81], v[80:81], v[84:85]
    v_pk_add_f32 v[82:83], v[82:83], v[86:87]
    s_waitcnt lgkmcnt(0)
    v_pk_add_f32 v[88:89], v[88:89], v[92:93]
    v_pk_add_f32 v[90:91], v[90:91], v[94:95]
    v_pk_add_f32 v[64:65], v[64:65], v[72:73]
    v_pk_add_f32 v[66:67], v[66:67], v[74:75]
    v_pk_add_f32 v[80:81], v[80:81], v[88:89]
    v_pk_add_f32 v[82:83], v[82:83], v[90:91]
    v_pk_add_f32 v[64:65], v[64:65], v[80:81]
    v_pk_add_f32 v[66:67], v[66:67], v[82:83]
    buffer_store_dwordx4 v[64:67], v1, s[60:63], s13 offen sc1
    s_branch L_H_done
L_ffn:
    s_lshl_b32 s9, s9, 3
    s_add_u32 s9, s9, s10
    s_sub_u32 s9, s9, 16
    s_mov_b32 s44, s28
    s_mov_b32 s45, s29
    s_mov_b32 s46, 1835008
    s_mov_b32 s47, 0x20000
    s_mov_b32 s68, s30
    s_mov_b32 s69, s31
    s_mov_b32 s70, 1835008
    s_mov_b32 s71, 0x20000
    s_movk_i32 s22, 0x400
    s_mov_b32 s23, 0x20000
    v_mul_u32_u24 v44, 3584, v40
    v_lshl_add_u32 v44, v41, 4, v44
    s_mul_i32 s48, s7, 458752
    s_lshl_b32 s5, s9, 6
    s_add_u32 s48, s48, s5
    v_lshlrev_b32 v48, 10, v2
    v_lshl_add_u32 v48, v3, 4, v48
    s_lshl_b32 s49, s9, 15
    s_lshl_b32 s5, s7, 8
    s_add_u32 s49, s49, s5
    s_lshl_b32 s5, s7, 9
    v_add_u32 v42, s5, v42
    v_lshl_add_u32 v29, v31, 13, v29
    v_add_u32 v29, s5, v29
    v_lshrrev_b32 v49, 1, v42
    buffer_load_dword v50, v49, s[20:23], 0 offen
    s_mov_b32 s10, 139264
    s_mov_b32 s11, 143360
    v_and_b32 v51, 7, v0
    v_lshl_add_u32 v51, v51, 2, v2
    v_lshlrev_b32 v51, 2, v51
    v_add_u32 v51, 35328, v51
    s_lshl_b32 s14, s9, 11
    s_lshl_b32 s5, s7, 9
    s_add_u32 s14, s14, s5
    s_add_u32 s14, s14, 155648
    s_lshl_b32 s5, s7, 3
    s_add_u32 s5, s5, 35168
    v_mov_b32 v52, s5
    v_mov_b32 v53, 35168
    s_mov_b32 s15, 0x3c000000
    s_mov_b32 s56, 0x43000000
    v_lshrrev_b32 v62, 3, v0
    v_lshlrev_b32 v62, 11, v62
    v_and_b32 v63, 7, v0
    v_lshlrev_b32 v63, 4, v63
    s_lshl_b32 s5, s9, 7
    v_add_u32 v63, s5, v63
    v_add_u32 v62, v62, v63
    s_waitcnt vmcnt(0)
    v_lshlrev_b32 v58, 16, v50
    v_and_b32 v59, 0xffff0000, v50
    s_lshl_b32 s5, s7, 2
    v_mov_b32 v30, s5
    v_cmp_eq_u32 vcc, 4, v0
    s_nop 1
    v_cndmask_b32 v30, v30, 48, vcc
    v_cmp_le_u32 vcc, 5, v0
    s_nop 1
    v_cndmask_b32 v30, v30, 56, vcc
    s_mov_b32 s75, 0x200000
L_gw23:
    ds_read_b32 v31, v30 offset:35104
    s_waitcnt lgkmcnt(0)
    v_cmp_eq_u32 vcc, -1, v31
    s_cbranch_vccz L_gwd24
    s_sub_u32 s75, s75, 1
    s_cbranch_scc1 L_gwd24
    s_sleep 1
    s_branch L_gw23
L_gwd24:
    v_mov_b32 v30, 35164
    s_mov_b32 s58, 0x200000
L_dw25:
    ds_read_b32 v31, v30
    s_waitcnt lgkmcnt(0)
    v_cmp_ne_u32 vcc, 4, v31
    s_cbranch_vccz L_dwd26
    s_sub_u32 s58, s58, 1
    s_cbranch_scc1 L_dwd26
    s_sleep 1
    s_branch L_dw25
L_dwd26:
    buffer_load_dwordx4 v[64:67], v44, s[44:47], s48 offen
    s_addk_i32 s48, 14336
    buffer_load_dwordx4 v[68:71], v44, s[44:47], s48 offen
    s_addk_i32 s48, 14336
    buffer_load_dwordx4 v[72:75], v44, s[44:47], s48 offen
    s_addk_i32 s48, 14336
    buffer_load_dwordx4 v[76:79], v44, s[44:47], s48 offen
    s_addk_i32 s48, 14336
    buffer_load_dwordx4 v[80:83], v44, s[44:47], s48 offen
    s_addk_i32 s48, 14336
    buffer_load_dwordx4 v[84:87], v44, s[44:47], s48 offen
    s_addk_i32 s48, 14336
    buffer_load_dwordx4 v[88:91], v44, s[44:47], s48 offen
    s_addk_i32 s48, 14336
    buffer_load_dwordx4 v[92:95], v44, s[44:47], s48 offen
    s_addk_i32 s48, 14336
    buffer_load_dwordx4 v[128:131], v48, s[68:71], s49 offen
    s_addk_i32 s49, 0x1000
    buffer_load_dwordx4 v[132:135], v48, s[68:71], s49 offen
    s_addk_i32 s49, 0x1000
    buffer_load_dwordx4 v[136:139], v48, s[68:71], s49 offen
    s_addk_i32 s49, 0x1000
    buffer_load_dwordx4 v[140:143], v48, s[68:71], s49 offen
    s_addk_i32 s49, 0x1000
    buffer_load_dwordx4 v[144:147], v48, s[68:71], s49 offen
    s_addk_i32 s49, 0x1000
    buffer_load_dwordx4 v[148:151], v48, s[68:71], s49 offen
    s_addk_i32 s49, 0x1000
    buffer_load_dwordx4 v[152:155], v48, s[68:71], s49 offen
    s_addk_i32 s49, 0x1000
    buffer_load_dwordx4 v[156:159], v48, s[68:71], s49 offen
    s_addk_i32 s49, 0x1000
    s_movk_i32 s75, 0xff
    s_movk_i32 s95, 0x1000
    s_mov_b32 s68, s32
    s_mov_b32 s69, s33
    s_mov_b32 s70, 1024
    s_mov_b32 s71, 0x20000
L_ps27:
    buffer_load_dwordx4 v[192:195], v29, s[60:63], s10 offen offset:0 sc1
    buffer_load_dwordx4 v[196:199], v29, s[60:63], s10 offen offset:2048 sc1
    buffer_load_dwordx4 v[200:203], v29, s[60:63], s11 offen offset:0 sc1
    buffer_load_dwordx4 v[204:207], v29, s[60:63], s11 offen offset:2048 sc1
    s_waitcnt vmcnt(0)
    v_pk_add_f32 v[32:33], v[192:193], v[196:197]
    v_pk_add_f32 v[34:35], v[194:195], v[198:199]
    v_pk_add_f32 v[36:37], v[200:201], v[204:205]
    v_pk_add_f32 v[38:39], v[202:203], v[206:207]
    v_pk_add_f32 v[32:33], v[32:33], v[36:37]
    v_pk_add_f32 v[34:35], v[34:35], v[38:39]
    s_nop 1
    v_permlane32_swap_b32 v32, v34
    v_permlane32_swap_b32 v33, v35
    v_pk_add_f32 v[32:33], v[32:33], v[34:35]
    v_cmp_u_f32 vcc, v32, v33
    s_cbranch_vccz L_psd28
    s_sub_u32 s75, s75, 1
    s_cbranch_scc0 L_ps27
    v_mov_b32 v46, 0
    v_max3_u32 v46, v46, v192, v193
    v_max3_u32 v46, v46, v194, v195
    v_max3_u32 v46, v46, v196, v197
    v_max3_u32 v46, v46, v198, v199
    v_max3_u32 v46, v46, v200, v201
    v_max3_u32 v46, v46, v202, v203
    v_max3_u32 v46, v46, v204, v205
    v_max3_u32 v46, v46, v206, v207
    v_cmp_eq_u32 vcc, -1, v46
    s_cbranch_vccz L_psd28
    s_movk_i32 s75, 0xff
    s_sub_u32 s95, s95, 1
    s_cbranch_scc0 L_ps27
L_psd28:
    v_cvt_pk_bf16_f32 v54, v32, v33
    v_and_b32 v55, 0xffff0000, v54
    v_lshlrev_b32 v54, 16, v54
    v_pk_add_f32 v[54:55], v[54:55], v[58:59]
    v_cvt_pk_bf16_f32 v54, v54, v55
    v_and_b32 v55, 0xffff0000, v54
    v_lshlrev_b32 v54, 16, v54
    s_nop 0
    v_readfirstlane_b32 s5, v54
    ds_write_b64 v42, v[54:55] offset:36352
    s_nop 0
    v_subrev_f32 v32, s5, v54
    v_subrev_f32 v33, s5, v55
    v_add_f32 v34, v32, v33
    v_mul_f32 v35, v32, v32
    v_fmac_f32 v35, v33, v33
    v_add_f32_dpp v34, v34, v34 quad_perm:[1,0,3,2] row_mask:0xf bank_mask:0xf
    s_nop 0
    v_add_f32_dpp v35, v35, v35 quad_perm:[1,0,3,2] row_mask:0xf bank_mask:0xf
    v_add_f32_dpp v34, v34, v34 quad_perm:[2,3,0,1] row_mask:0xf bank_mask:0xf
    s_nop 0
    v_add_f32_dpp v35, v35, v35 quad_perm:[2,3,0,1] row_mask:0xf bank_mask:0xf
    v_add_f32_dpp v34, v34, v34 row_half_mirror row_mask:0xf bank_mask:0xf
    s_nop 0
    v_add_f32_dpp v35, v35, v35 row_half_mirror row_mask:0xf bank_mask:0xf
    v_add_f32_dpp v34, v34, v34 row_mirror row_mask:0xf bank_mask:0xf
    s_nop 0
    v_add_f32_dpp v35, v35, v35 row_mirror row_mask:0xf bank_mask:0xf
    v_mov_b32 v36, v34
    v_mov_b32 v37, v35
    s_nop 0
    v_permlane16_swap_b32 v34, v36
    v_permlane16_swap_b32 v35, v37
    v_add_f32 v34, v34, v36
    v_add_f32 v35, v35, v37
    v_mov_b32 v36, v34
    v_mov_b32 v37, v35
    s_nop 0
    v_permlane32_swap_b32 v34, v36
    v_permlane32_swap_b32 v35, v37
    v_add_f32 v34, v34, v36
    v_add_f32 v35, v35, v37
    v_mul_f32 v36, s15, v34
    v_fma_f32 v35, -v36, v34, v35
    v_add_f32 v34, s5, v36
    ds_write_b64 v52, v[34:35]
    s_waitcnt lgkmcnt(0)
    s_barrier
    ds_read_b128 v[32:35], v53
    ds_read_b128 v[36:39], v53 offset:16
    s_waitcnt lgkmcnt(0)
    v_pk_add_f32 v[56:57], v[32:33], v[34:35]
    v_pk_add_f32 v[60:61], v[36:37], v[38:39]
    v_pk_add_f32 v[56:57], v[56:57], v[60:61]
    v_mul_f32 v56, 0.25, v56
    v_sub_f32 v32, v32, v56
    v_sub_f32 v34, v34, v56
    v_sub_f32 v36, v36, v56
    v_sub_f32 v38, v38, v56
    v_mul_f32 v33, v32, v32
    v_fmac_f32 v33, v34, v34
    v_fmac_f32 v33, v36, v36
    v_fmac_f32 v33, v38, v38
    v_fmac_f32 v57, s56, v33
    v_mul_f32 v60, s72, v57
    v_cvt_pk_bf16_f32 v60, v60, v60
    v_and_b32 v60, 0xffff0000, v60
    v_add_f32 v60, s73, v60
    v_cvt_pk_bf16_f32 v60, v60, v60
    v_and_b32 v60, 0xffff0000, v60
    v_sqrt_f32 v60, v60
    v_cvt_pk_bf16_f32 v56, v56, v56
    v_and_b32 v56, 0xffff0000, v56
    v_cvt_pk_bf16_f32 v60, v60, v60
    v_and_b32 v60, 0xffff0000, v60
    v_rcp_f32 v61, v60
    v_sub_f32 v54, v54, v56
    v_sub_f32 v55, v55, v56
    v_cvt_pk_bf16_f32 v54, v54, v54
    v_cvt_pk_bf16_f32 v55, v55, v55
    v_and_b32 v54, 0xffff0000, v54
    v_and_b32 v55, 0xffff0000, v55
    v_mul_f32 v32, v54, v61
    v_mul_f32 v33, v55, v61
    v_fma_f32 v54, -v32, v60, v54
    v_fma_f32 v55, -v33, v60, v55
    v_fma_f32 v54, v54, v61, v32
    v_fma_f32 v55, v55, v61, v33
    v_cvt_pk_bf16_f32 v47, v54, v55
    s_nop 1
    v_mov_b32_dpp v45, v47 row_newbcast:0 row_mask:0xf bank_mask:0xf
    v_perm_b32 v12, v45, v45, v8
    v_perm_b32 v13, v45, v45, v9
    v_perm_b32 v14, v45, v45, v10
    v_perm_b32 v15, v45, v45, v11
    v_mov_b32_dpp v45, v47 row_newbcast:8 row_mask:0xf bank_mask:0xf
    v_perm_b32 v16, v45, v45, v8
    v_perm_b32 v17, v45, v45, v9
    v_perm_b32 v18, v45, v45, v10
    v_perm_b32 v19, v45, v45, v11
    v_mfma_f32_16x16x32_bf16 v[20:23], v[12:15], v[64:67], 0
    v_mov_b32_dpp v45, v47 row_newbcast:1 row_mask:0xf bank_mask:0xf
    v_perm_b32 v12, v45, v45, v8
    v_perm_b32 v13, v45, v45, v9
    v_perm_b32 v14, v45, v45, v10
    v_perm_b32 v15, v45, v45, v11
    v_mfma_f32_16x16x32_bf16 v[24:27], v[16:19], v[64:67], 0
    v_mov_b32_dpp v45, v47 row_newbcast:9 row_mask:0xf bank_mask:0xf
    v_perm_b32 v16, v45, v45, v8
    v_perm_b32 v17, v45, v45, v9
    v_perm_b32 v18, v45, v45, v10
    v_perm_b32 v19, v45, v45, v11
    v_mfma_f32_16x16x32_bf16 v[20:23], v[12:15], v[68:71], v[20:23]
    v_mov_b32_dpp v45, v47 row_newbcast:2 row_mask:0xf bank_mask:0xf
    v_perm_b32 v12, v45, v45, v8
    v_perm_b32 v13, v45, v45, v9
    v_perm_b32 v14, v45, v45, v10
    v_perm_b32 v15, v45, v45, v11
    v_mfma_f32_16x16x32_bf16 v[24:27], v[16:19], v[68:71], v[24:27]
    v_mov_b32_dpp v45, v47 row_newbcast:10 row_mask:0xf bank_mask:0xf
    v_perm_b32 v16, v45, v45, v8
    v_perm_b32 v17, v45, v45, v9
    v_perm_b32 v18, v45, v45, v10
    v_perm_b32 v19, v45, v45, v11
    v_mfma_f32_16x16x32_bf16 v[20:23], v[12:15], v[72:75], v[20:23]
    v_mov_b32_dpp v45, v47 row_newbcast:3 row_mask:0xf bank_mask:0xf
    v_perm_b32 v12, v45, v45, v8
    v_perm_b32 v13, v45, v45, v9
    v_perm_b32 v14, v45, v45, v10
    v_perm_b32 v15, v45, v45, v11
    v_mfma_f32_16x16x32_bf16 v[24:27], v[16:19], v[72:75], v[24:27]
    v_mov_b32_dpp v45, v47 row_newbcast:11 row_mask:0xf bank_mask:0xf
    v_perm_b32 v16, v45, v45, v8
    v_perm_b32 v17, v45, v45, v9
    v_perm_b32 v18, v45, v45, v10
    v_perm_b32 v19, v45, v45, v11
    v_mfma_f32_16x16x32_bf16 v[20:23], v[12:15], v[76:79], v[20:23]
    v_mov_b32_dpp v45, v47 row_newbcast:4 row_mask:0xf bank_mask:0xf
    v_perm_b32 v12, v45, v45, v8
    v_perm_b32 v13, v45, v45, v9
    v_perm_b32 v14, v45, v45, v10
    v_perm_b32 v15, v45, v45, v11
    v_mfma_f32_16x16x32_bf16 v[24:27], v[16:19], v[76:79], v[24:27]
    v_mov_b32_dpp v45, v47 row_newbcast:12 row_mask:0xf bank_mask:0xf
    v_perm_b32 v16, v45, v45, v8
    v_perm_b32 v17, v45, v45, v9
    v_perm_b32 v18, v45, v45, v10
    v_perm_b32 v19, v45, v45, v11
    v_mfma_f32_16x16x32_bf16 v[20:23], v[12:15], v[80:83], v[20:23]
    v_mov_b32_dpp v45, v47 row_newbcast:5 row_mask:0xf bank_mask:0xf
    v_perm_b32 v12, v45, v45, v8
    v_perm_b32 v13, v45, v45, v9
    v_perm_b32 v14, v45, v45, v10
    v_perm_b32 v15, v45, v45, v11
    v_mfma_f32_16x16x32_bf16 v[24:27], v[16:19], v[80:83], v[24:27]
    v_mov_b32_dpp v45, v47 row_newbcast:13 row_mask:0xf bank_mask:0xf
    v_perm_b32 v16, v45, v45, v8
    v_perm_b32 v17, v45, v45, v9
    v_perm_b32 v18, v45, v45, v10
    v_perm_b32 v19, v45, v45, v11
    v_mfma_f32_16x16x32_bf16 v[20:23], v[12:15], v[84:87], v[20:23]
    v_mov_b32_dpp v45, v47 row_newbcast:6 row_mask:0xf bank_mask:0xf
    v_perm_b32 v12, v45, v45, v8
    v_perm_b32 v13, v45, v45, v9
    v_perm_b32 v14, v45, v45, v10
    v_perm_b32 v15, v45, v45, v11
    v_mfma_f32_16x16x32_bf16 v[24:27], v[16:19], v[84:87], v[24:27]
    v_mov_b32_dpp v45, v47 row_newbcast:14 row_mask:0xf bank_mask:0xf
    v_perm_b32 v16, v45, v45, v8
    v_perm_b32 v17, v45, v45, v9
    v_perm_b32 v18, v45, v45, v10
    v_perm_b32 v19, v45, v45, v11
    v_mfma_f32_16x16x32_bf16 v[20:23], v[12:15], v[88:91], v[20:23]
    v_mov_b32_dpp v45, v47 row_newbcast:7 row_mask:0xf bank_mask:0xf
    v_perm_b32 v12, v45, v45, v8
    v_perm_b32 v13, v45, v45, v9
    v_perm_b32 v14, v45, v45, v10
    v_perm_b32 v15, v45, v45, v11
    v_mfma_f32_16x16x32_bf16 v[24:27], v[16:19], v[88:91], v[24:27]
    v_mov_b32_dpp v45, v47 row_newbcast:15 row_mask:0xf bank_mask:0xf
    v_perm_b32 v16, v45, v45, v8
    v_perm_b32 v17, v45, v45, v9
    v_perm_b32 v18, v45, v45, v10
    v_perm_b32 v19, v45, v45, v11
    v_mfma_f32_16x16x32_bf16 v[20:23], v[12:15], v[92:95], v[20:23]
    s_nop 0
    v_mfma_f32_16x16x32_bf16 v[24:27], v[16:19], v[92:95], v[24:27]
    s_nop 7
    v_add_f32_dpp v20, v24, v20 row_ror:8 row_mask:0xf bank_mask:0xf
    v_add_f32_dpp v21, v25, v21 row_ror:8 row_mask:0xf bank_mask:0xf
    v_add_f32_dpp v22, v26, v22 row_ror:8 row_mask:0xf bank_mask:0xf
    v_add_f32_dpp v23, v27, v23 row_ror:8 row_mask:0xf bank_mask:0xf
    s_mov_b32 exec_lo, 0x000f000f
    s_mov_b32 exec_hi, 0x00f000f0
    ds_write_b128 v43, v[20:23] offset:35328
    s_mov_b64 exec, -1
    s_waitcnt lgkmcnt(0)
    s_barrier
    ds_read2_b32 v[32:33], v51 offset0:0 offset1:32
    ds_read2_b32 v[34:35], v51 offset0:64 offset1:96
    ds_read2_b32 v[36:37], v51 offset0:128 offset1:160
    ds_read2_b32 v[38:39], v51 offset0:192 offset1:224
    v_mov_b32 v20, 0
    v_mov_b32 v21, 0
    v_mov_b32 v22, 0
    v_mov_b32 v23, 0
    s_waitcnt lgkmcnt(2)
    v_pk_add_f32 v[32:33], v[32:33], v[34:35]
    s_waitcnt lgkmcnt(0)
    v_pk_add_f32 v[36:37], v[36:37], v[38:39]
    v_pk_add_f32 v[32:33], v[32:33], v[36:37]
    v_add_f32 v32, v32, v33
    v_cvt_pk_bf16_f32 v32, v32, v32
    v_and_b32 v32, 0xffff0000, v32
    v_mul_f32 v33, s57, v32
    v_exp_f32 v33, -v33
    s_nop 0
    v_add_f32 v33, 1.0, v33
    v_rcp_f32 v34, v33
    s_nop 0
    v_mul_f32 v32, v32, v34
    v_cvt_pk_bf16_f32 v47, v32, v32
    s_nop 1
    v_and_b32_dpp v12, v47, v4 row_newbcast:0 row_mask:0xf bank_mask:0xf
    v_and_b32_dpp v13, v47, v5 row_newbcast:0 row_mask:0xf bank_mask:0xf
    v_and_b32_dpp v14, v47, v6 row_newbcast:0 row_mask:0xf bank_mask:0xf
    v_and_b32_dpp v15, v47, v7 row_newbcast:0 row_mask:0xf bank_mask:0xf
    v_and_b32_dpp v16, v47, v4 row_newbcast:1 row_mask:0xf bank_mask:0xf
    v_and_b32_dpp v17, v47, v5 row_newbcast:1 row_mask:0xf bank_mask:0xf
    v_and_b32_dpp v18, v47, v6 row_newbcast:1 row_mask:0xf bank_mask:0xf
    v_and_b32_dpp v19, v47, v7 row_newbcast:1 row_mask:0xf bank_mask:0xf
    v_mfma_f32_16x16x32_bf16 v[20:23], v[12:15], v[128:131], v[20:23]
    v_and_b32_dpp v12, v47, v4 row_newbcast:2 row_mask:0xf bank_mask:0xf
    v_and_b32_dpp v13, v47, v5 row_newbcast:2 row_mask:0xf bank_mask:0xf
    v_and_b32_dpp v14, v47, v6 row_newbcast:2 row_mask:0xf bank_mask:0xf
    v_and_b32_dpp v15, v47, v7 row_newbcast:2 row_mask:0xf bank_mask:0xf
    v_mfma_f32_16x16x32_bf16 v[20:23], v[16:19], v[132:135], v[20:23]
    v_and_b32_dpp v16, v47, v4 row_newbcast:3 row_mask:0xf bank_mask:0xf
    v_and_b32_dpp v17, v47, v5 row_newbcast:3 row_mask:0xf bank_mask:0xf
    v_and_b32_dpp v18, v47, v6 row_newbcast:3 row_mask:0xf bank_mask:0xf
    v_and_b32_dpp v19, v47, v7 row_newbcast:3 row_mask:0xf bank_mask:0xf
    v_mfma_f32_16x16x32_bf16 v[20:23], v[12:15], v[136:139], v[20:23]
    v_and_b32_dpp v12, v47, v4 row_newbcast:4 row_mask:0xf bank_mask:0xf
    v_and_b32_dpp v13, v47, v5 row_newbcast:4 row_mask:0xf bank_mask:0xf
    v_and_b32_dpp v14, v47, v6 row_newbcast:4 row_mask:0xf bank_mask:0xf
    v_and_b32_dpp v15, v47, v7 row_newbcast:4 row_mask:0xf bank_mask:0xf
    v_mfma_f32_16x16x32_bf16 v[20:23], v[16:19], v[140:143], v[20:23]
    v_and_b32_dpp v16, v47, v4 row_newbcast:5 row_mask:0xf bank_mask:0xf
    v_and_b32_dpp v17, v47, v5 row_newbcast:5 row_mask:0xf bank_mask:0xf
    v_and_b32_dpp v18, v47, v6 row_newbcast:5 row_mask:0xf bank_mask:0xf
    v_and_b32_dpp v19, v47, v7 row_newbcast:5 row_mask:0xf bank_mask:0xf
    v_mfma_f32_16x16x32_bf16 v[20:23], v[12:15], v[144:147], v[20:23]
    v_and_b32_dpp v12, v47, v4 row_newbcast:6 row_mask:0xf bank_mask:0xf
    v_and_b32_dpp v13, v47, v5 row_newbcast:6 row_mask:0xf bank_mask:0xf
    v_and_b32_dpp v14, v47, v6 row_newbcast:6 row_mask:0xf bank_mask:0xf
    v_and_b32_dpp v15, v47, v7 row_newbcast:6 row_mask:0xf bank_mask:0xf
    v_mfma_f32_16x16x32_bf16 v[20:23], v[16:19], v[148:151], v[20:23]
    v_and_b32_dpp v16, v47, v4 row_newbcast:7 row_mask:0xf bank_mask:0xf
    v_and_b32_dpp v17, v47, v5 row_newbcast:7 row_mask:0xf bank_mask:0xf
    v_and_b32_dpp v18, v47, v6 row_newbcast:7 row_mask:0xf bank_mask:0xf
    v_and_b32_dpp v19, v47, v7 row_newbcast:7 row_mask:0xf bank_mask:0xf
    v_mfma_f32_16x16x32_bf16 v[20:23], v[12:15], v[152:155], v[20:23]
    s_nop 0
    v_mfma_f32_16x16x32_bf16 v[20:23], v[16:19], v[156:159], v[20:23]
    s_mov_b32 exec_lo, 0xffffffff
    s_mov_b32 exec_hi, 0
    s_nop 5
    buffer_store_dwordx4 v[20:23], v28, s[60:63], s14 offen sc1
    s_mov_b64 exec, -1
    s_cmp_ge_u32 s9, 16
    s_cbranch_scc1 L_H_done
    s_cmp_lg_u32 s7, 0
    s_cbranch_scc1 L_H_done
    ds_read_b128 v[36:39], v63 offset:36352
    s_mov_b32 s8, 155648
    s_mov_b32 s9, 172032
    s_mov_b32 s10, 188416
    s_mov_b32 s11, 204800
    s_mov_b32 s12, 221184
    s_mov_b32 s13, 237568
    s_mov_b32 s14, 253952
    s_movk_i32 s75, 0xff
    s_movk_i32 s95, 0x1000
    v_lshrrev_b32 v49, 1, v63
L_ps29:
    buffer_load_dwordx4 v[64:67], v62, s[60:63], s8 offen sc1
    buffer_load_dwordx4 v[68:71], v62, s[60:63], s9 offen sc1
    buffer_load_dwordx4 v[72:75], v62, s[60:63], s10 offen sc1
    buffer_load_dwordx4 v[76:79], v62, s[60:63], s11 offen sc1
    buffer_load_dwordx4 v[80:83], v62, s[60:63], s12 offen sc1
    buffer_load_dwordx4 v[84:87], v62, s[60:63], s13 offen sc1
    buffer_load_dwordx4 v[88:91], v62, s[60:63], s14 offen sc1
    s_waitcnt vmcnt(0)
    v_pk_add_f32 v[96:97], v[64:65], v[68:69]
    v_pk_add_f32 v[98:99], v[66:67], v[70:71]
    v_pk_add_f32 v[100:101], v[72:73], v[76:77]
    v_pk_add_f32 v[102:103], v[74:75], v[78:79]
    v_pk_add_f32 v[104:105], v[80:81], v[84:85]
    v_pk_add_f32 v[106:107], v[82:83], v[86:87]
    v_pk_add_f32 v[96:97], v[96:97], v[100:101]
    v_pk_add_f32 v[98:99], v[98:99], v[102:103]
    v_pk_add_f32 v[104:105], v[104:105], v[88:89]
    v_pk_add_f32 v[106:107], v[106:107], v[90:91]
    v_pk_add_f32 v[96:97], v[96:97], v[104:105]
    v_pk_add_f32 v[98:99], v[98:99], v[106:107]
    s_nop 0
    v_add_f32_dpp v96, v96, v96 row_ror:8 row_mask:0xf bank_mask:0xf
    v_add_f32_dpp v97, v97, v97 row_ror:8 row_mask:0xf bank_mask:0xf
    v_add_f32_dpp v98, v98, v98 row_ror:8 row_mask:0xf bank_mask:0xf
    v_add_f32_dpp v99, v99, v99 row_ror:8 row_mask:0xf bank_mask:0xf
    v_mov_b32 v100, v96
    v_mov_b32 v101, v97
    v_mov_b32 v102, v98
    v_mov_b32 v103, v99
    v_permlane16_swap_b32 v96, v100
    v_permlane16_swap_b32 v97, v101
    v_permlane16_swap_b32 v98, v102
    v_permlane16_swap_b32 v99, v103
    v_pk_add_f32 v[96:97], v[96:97], v[100:101]
    v_pk_add_f32 v[98:99], v[98:99], v[102:103]
    v_mov_b32 v100, v96
    v_mov_b32 v101, v97
    v_mov_b32 v102, v98
    v_mov_b32 v103, v99
    v_permlane32_swap_b32 v96, v100
    v_permlane32_swap_b32 v97, v101
    v_permlane32_swap_b32 v98, v102
    v_permlane32_swap_b32 v99, v103
    v_pk_add_f32 v[96:97], v[96:97], v[100:101]
    v_pk_add_f32 v[98:99], v[98:99], v[102:103]
    v_cmp_u_f32 vcc, v96, v97
    v_cmp_u_f32 s[58:59], v98, v99
    s_or_b64 s[58:59], vcc, s[58:59]
    s_cbranch_scc0 L_psd30
    s_sub_u32 s75, s75, 1
    s_cbranch_scc0 L_ps29
    v_mov_b32 v46, 0
    v_max3_u32 v46, v46, v64, v65
    v_max3_u32 v46, v46, v66, v67
    v_max3_u32 v46, v46, v68, v69
    v_max3_u32 v46, v46, v70, v71
    v_max3_u32 v46, v46, v72, v73
    v_max3_u32 v46, v46, v74, v75
    v_max3_u32 v46, v46, v76, v77
    v_max3_u32 v46, v46, v78, v79
    v_max3_u32 v46, v46, v80, v81
    v_max3_u32 v46, v46, v82, v83
    v_max3_u32 v46, v46, v84, v85
    v_max3_u32 v46, v46, v86, v87
    v_max3_u32 v46, v46, v88, v89
    v_max3_u32 v46, v46, v90, v91
    v_cmp_eq_u32 vcc, -1, v46
    s_cbranch_vccz L_psd30
    s_movk_i32 s75, 0xff
    s_sub_u32 s95, s95, 1
    s_cbranch_scc0 L_ps29
L_psd30:
    v_cvt_pk_bf16_f32 v100, v96, v97
    v_cvt_pk_bf16_f32 v101, v98, v99
    v_lshlrev_b32 v96, 16, v100
    v_and_b32 v97, 0xffff0000, v100
    v_lshlrev_b32 v98, 16, v101
    v_and_b32 v99, 0xffff0000, v101
    s_waitcnt lgkmcnt(0)
    v_pk_add_f32 v[96:97], v[96:97], v[36:37]
    v_pk_add_f32 v[98:99], v[98:99], v[38:39]
    v_cvt_pk_bf16_f32 v100, v96, v97
    v_cvt_pk_bf16_f32 v101, v98, v99
    s_mov_b32 exec_lo, 0xff
    s_mov_b32 exec_hi, 0
    buffer_store_dwordx2 v[100:101], v49, s[68:71], 0 offen
    s_cmp_lg_u32 s2, 128
    s_cbranch_scc1 L_noepo
    s_mov_b32 exec_lo, 0x1
    s_mov_b32 exec_hi, 0
    v_mov_b32 v32, s93
    v_mov_b32 v33, 532484
    buffer_store_dword v32, v33, s[60:63], 0 offen
L_noepo:
L_H_done:
    s_waitcnt lgkmcnt(0)
L_end:
    s_endpgm
.section .rodata,"a"
.p2align 6
.amdhsa_kernel sequential_preLN__mha_block_cached__dense_activation_silu__decode_kernel
  .amdhsa_next_free_vgpr 256
  .amdhsa_next_free_sgpr 102
  .amdhsa_accum_offset 256
  .amdhsa_group_segment_fixed_size 0
  .amdhsa_kernarg_size 88
  .amdhsa_user_sgpr_count 2
  .amdhsa_user_sgpr_kernarg_segment_ptr 1
  .amdhsa_system_sgpr_workgroup_id_x 1
  .amdhsa_float_denorm_mode_32 3
.end_amdhsa_kernel
```
